```python
import torch

def _softmax(x, axis=-1):
    return torch.softmax(x, dim=axis)
def _gelu(x):
    return torch.nn.functional.gelu(x, approximate="tanh")
def _silu(x):
    return torch.nn.functional.silu(x)
def _sigmoid(x):
    return torch.sigmoid(x)
def _layernorm(x, axis=-1, eps=1e-5):
    m = x.mean(dim=axis, keepdim=True)
    v = x.var(dim=axis, keepdim=True, unbiased=False)
    return (x - m) / torch.sqrt(v + eps)
def _scatter_add(tgt, idx, src, axis=0):
    return tgt.clone().index_add_(axis, idx, src)
def _segment_sum(src, seg, n):
    out = torch.zeros((n,) + src.shape[1:], dtype=src.dtype)
    return out.index_add_(0, seg, src)
def _pad(x, pw):
    flat = tuple(v for pair in reversed(pw) for v in pair)
    return torch.nn.functional.pad(x, flat)

kernel_name = 'sequential_preLN__spectral_gfnet__dense_activation_mish__prompt'

def setup_inputs():

    _w = (lambda a: (lambda t: t.to(torch.bfloat16) if t.is_floating_point() else t)(torch.as_tensor(a)))
    def _A_setup():
        B, S, D = 1, 2048, 512
        Df = D // 2 + 1
        return {
            "x": _w((lambda *s: torch.randn(*s, dtype=torch.bfloat16) * 0.05)(B, S, D)),
            "w_r": _w((lambda *s: torch.randn(*s, dtype=torch.bfloat16) * 0.4)(S, Df) * 0.02),
            "w_i": _w((lambda *s: torch.randn(*s, dtype=torch.bfloat16) * 0.4)(S, Df) * 0.02),
        }
    _A_in = _A_setup()

    def _B_setup():
        B, S, D, F = 1, 2048, 512, 1792
        return {
            "x": _w((lambda *s: torch.randn(*s, dtype=torch.bfloat16) * 0.05)(B, S, D)),
            "w1": _w((lambda *s: torch.randn(*s, dtype=torch.bfloat16) * 0.8)(D, F) * (D ** -0.5)),
            "b1": _w((lambda *s: torch.randn(*s, dtype=torch.bfloat16) * 0.2)(F)),
            "w2": _w((lambda *s: torch.randn(*s, dtype=torch.bfloat16) * 0.1)(F, D) * (F ** -0.5)),
        }
    _B_in = _B_setup()

    return {
        "A_x": _A_in["x"],
        "A_w_r": _A_in["w_r"],
        "A_w_i": _A_in["w_i"],
        "B_x": _B_in["x"],
        "B_w1": _B_in["w1"],
        "B_b1": _B_in["b1"],
        "B_w2": _B_in["w2"],
    }

def reference(A_x, A_w_r, A_w_i, B_x, B_w1, B_b1, B_w2):
    def _A_ref(x, w_r, w_i):
        B, S, D = x.shape
        X = (lambda x, axes=(-2,-1): torch.fft.rfft2(x.float(), dim=axes))(x, axes=(-2, -1))
        W = w_r + 1j * w_i
        X = X * W
        y = (lambda x, s, axes=(-2,-1): torch.fft.irfft2(x, s=s, dim=axes).to(torch.bfloat16))(X, (S, D), axes=(-2, -1))
        return y

    def _B_ref(x, w1, b1, w2):
        h = torch.einsum("bsd,df->bsf", x, w1) + b1
        sp = torch.log1p(torch.exp(-torch.abs(h))) + torch.where(h > 0, h, torch.zeros_like(h))
        act = h * torch.tanh(sp)
        return torch.einsum("bsf,fd->bsd", act, w2)

    x = A_x
    h = x + _A_ref(_layernorm(x, axis=-1), A_w_r, A_w_i)
    h2 = h + _B_ref(_layernorm(h, axis=-1), B_w1, B_b1, B_w2)
    return h2
```

```asm
; @launch grid=(256,1,1) block=(256,1,1) lds=163840
.amdgcn_target "amdgcn-amd-amdhsa--gfx950"
.text
.globl sequential_preLN__spectral_gfnet__dense_activation_mish__prompt_kernel
.p2align 8
.type sequential_preLN__spectral_gfnet__dense_activation_mish__prompt_kernel,@function
sequential_preLN__spectral_gfnet__dense_activation_mish__prompt_kernel:
  s_cmp_ge_u32 s2, 256
  s_cbranch_scc1 L_END
  s_load_dwordx4 s[4:7], s[0:1], 0
  s_load_dwordx4 s[20:23], s[0:1], 64
  s_load_dwordx2 s[8:9], s[0:1], 16
  s_load_dwordx4 s[12:15], s[0:1], 32
  s_load_dwordx4 s[16:19], s[0:1], 48
  s_getpc_b64 s[98:99]
L_PCREF:
  v_lshlrev_b32 v4, 7, v0
  v_min_u32 v4, L_END-L_PCREF, v4
  global_load_dword v234, v4, s[98:99]
  v_and_b32 v1, 63, v0
  v_lshrrev_b32 v4, 6, v0
  s_nop 0
  v_readfirstlane_b32 s40, v4
  s_and_b32 s41, s2, 7
  s_lshr_b32 s46, s2, 5
  s_lshl_b32 s43, s46, 3
  s_add_u32 s43, s43, s41
  s_waitcnt lgkmcnt(0)
  s_add_u32 s34, s22, 0x1000000
  s_addc_u32 s35, s23, 0
  s_cmp_eq_u32 s2, 0
  s_cselect_b32 s48, s40, 0
  s_cmp_eq_u32 s48, 3
  s_cbranch_scc0 L_NOZERO
  v_lshlrev_b32 v4, 8, v1
  v_mov_b32 v5, 0
  global_store_dword v4, v5, s[34:35] sc1
  v_add_u32 v4, 0x4000, v4
  global_store_dword v4, v5, s[34:35] sc1
  s_nop 0
L_NOZERO:
  s_lshl_b32 s48, s40, 9
  s_add_u32 s48, s48, s43
  s_lshl_b32 s48, s48, 10
  v_lshl_add_u32 v128, v1, 4, s48
  s_mul_i32 s49, s40, 8448
  s_add_u32 s49, s49, 114688
  s_add_u32 m0, s49, 0
  s_nop 0
  global_load_lds_dwordx4 v128, s[4:5]
  v_add_u32 v128, 0x10000, v128
  s_add_u32 m0, s49, 1056
  s_nop 0
  global_load_lds_dwordx4 v128, s[4:5]
  v_add_u32 v128, 0x10000, v128
  s_add_u32 m0, s49, 2112
  s_nop 0
  global_load_lds_dwordx4 v128, s[4:5]
  v_add_u32 v128, 0x10000, v128
  s_add_u32 m0, s49, 3168
  s_nop 0
  global_load_lds_dwordx4 v128, s[4:5]
  v_add_u32 v128, 0x10000, v128
  s_add_u32 m0, s49, 4224
  s_nop 0
  global_load_lds_dwordx4 v128, s[4:5]
  v_add_u32 v128, 0x10000, v128
  s_add_u32 m0, s49, 5280
  s_nop 0
  global_load_lds_dwordx4 v128, s[4:5]
  v_add_u32 v128, 0x10000, v128
  s_add_u32 m0, s49, 6336
  s_nop 0
  global_load_lds_dwordx4 v128, s[4:5]
  v_add_u32 v128, 0x10000, v128
  s_add_u32 m0, s49, 7392
  s_nop 0
  global_load_lds_dwordx4 v128, s[4:5]
  v_and_b32 v2, 15, v0
  v_bfe_u32 v3, v0, 4, 2
  s_bfe_u32 s42, s2, 0x20003
  s_bfe_u32 s44, s2, 0x40003
  s_and_b32 s45, s2, 31
  s_lshr_b32 s47, s2, 7
  s_mov_b32 s64, 0x3f803f80
  s_mov_b32 s65, 0x05040100
  s_mov_b32 s66, 0x07060302
  s_mov_b32 s67, 0x80008000
  s_add_u32 s24, s22, 0x0
  s_addc_u32 s25, s23, 0
  s_add_u32 s26, s22, 0x200000
  s_addc_u32 s27, s23, 0
  s_add_u32 s28, s22, 0x400000
  s_addc_u32 s29, s23, 0
  s_add_u32 s30, s22, 0x600000
  s_addc_u32 s31, s23, 0
  s_add_u32 s32, s22, 0x800000
  s_addc_u32 s33, s23, 0
  s_mul_i32 s70, s40, 28672
  s_mul_i32 s48, s44, 224
  s_mul_i32 s49, s40, 458752
  s_add_u32 s48, s48, s49
  s_add_u32 s36, s12, s48
  s_addc_u32 s37, s13, 0
  s_mov_b32 s38, -1
  s_mov_b32 s39, 0x00ffffff
  s_and_b32 s48, s44, 7
  s_lshl_b32 s48, s48, 2
  s_add_u32 s48, s48, s40
  s_mul_i32 s48, s48, 57344
  s_add_u32 s48, s48, 0x1200000
  s_add_u32 s68, s22, s48
  s_addc_u32 s69, s23, 0
  s_lshl_b32 s48, s42, 6
  s_add_u32 s48, s48, s40
  v_lshl_add_u32 v10, v2, 2, s48
  v_cmp_eq_u32 vcc, 0, v10
  v_mov_b32 v11, 0x100
  s_nop 0
  v_cndmask_b32 v10, v10, v11, vcc
  v_cvt_f32_u32 v10, v10
  v_mul_f32 v10, 0x3b000000, v10
  v_lshlrev_b32 v11, 3, v3
  v_cvt_f32_u32 v11, v11
  v_mul_f32 v11, v10, v11
  v_mov_b32 v4, v11
  v_fmamk_f32 v5, v10, 0x3f800000, v11
  v_cos_f32 v6, v4
  v_cos_f32 v7, v5
  v_sin_f32_e64 v8, -v4
  v_sin_f32_e64 v9, -v5
  v_cvt_pk_bf16_f32 v16, v6, v7
  v_cvt_pk_bf16_f32 v32, v8, v9
  v_fmamk_f32 v4, v10, 0x40000000, v11
  v_fmamk_f32 v5, v10, 0x40400000, v11
  v_cos_f32 v6, v4
  v_cos_f32 v7, v5
  v_sin_f32_e64 v8, -v4
  v_sin_f32_e64 v9, -v5
  v_cvt_pk_bf16_f32 v17, v6, v7
  v_cvt_pk_bf16_f32 v33, v8, v9
  v_fmamk_f32 v4, v10, 0x40800000, v11
  v_fmamk_f32 v5, v10, 0x40a00000, v11
  v_cos_f32 v6, v4
  v_cos_f32 v7, v5
  v_sin_f32_e64 v8, -v4
  v_sin_f32_e64 v9, -v5
  v_cvt_pk_bf16_f32 v18, v6, v7
  v_cvt_pk_bf16_f32 v34, v8, v9
  v_fmamk_f32 v4, v10, 0x40c00000, v11
  v_fmamk_f32 v5, v10, 0x40e00000, v11
  v_cos_f32 v6, v4
  v_cos_f32 v7, v5
  v_sin_f32_e64 v8, -v4
  v_sin_f32_e64 v9, -v5
  v_cvt_pk_bf16_f32 v19, v6, v7
  v_cvt_pk_bf16_f32 v35, v8, v9
  v_fmamk_f32 v4, v10, 0x42000000, v11
  v_fmamk_f32 v5, v10, 0x42040000, v11
  v_cos_f32 v6, v4
  v_cos_f32 v7, v5
  v_sin_f32_e64 v8, -v4
  v_sin_f32_e64 v9, -v5
  v_cvt_pk_bf16_f32 v20, v6, v7
  v_cvt_pk_bf16_f32 v36, v8, v9
  v_fmamk_f32 v4, v10, 0x42080000, v11
  v_fmamk_f32 v5, v10, 0x420c0000, v11
  v_cos_f32 v6, v4
  v_cos_f32 v7, v5
  v_sin_f32_e64 v8, -v4
  v_sin_f32_e64 v9, -v5
  v_cvt_pk_bf16_f32 v21, v6, v7
  v_cvt_pk_bf16_f32 v37, v8, v9
  v_fmamk_f32 v4, v10, 0x42100000, v11
  v_fmamk_f32 v5, v10, 0x42140000, v11
  v_cos_f32 v6, v4
  v_cos_f32 v7, v5
  v_sin_f32_e64 v8, -v4
  v_sin_f32_e64 v9, -v5
  v_cvt_pk_bf16_f32 v22, v6, v7
  v_cvt_pk_bf16_f32 v38, v8, v9
  v_fmamk_f32 v4, v10, 0x42180000, v11
  v_fmamk_f32 v5, v10, 0x421c0000, v11
  v_cos_f32 v6, v4
  v_cos_f32 v7, v5
  v_sin_f32_e64 v8, -v4
  v_sin_f32_e64 v9, -v5
  v_cvt_pk_bf16_f32 v23, v6, v7
  v_cvt_pk_bf16_f32 v39, v8, v9
  v_fmamk_f32 v4, v10, 0x42800000, v11
  v_fmamk_f32 v5, v10, 0x42820000, v11
  v_cos_f32 v6, v4
  v_cos_f32 v7, v5
  v_sin_f32_e64 v8, -v4
  v_sin_f32_e64 v9, -v5
  v_cvt_pk_bf16_f32 v24, v6, v7
  v_cvt_pk_bf16_f32 v40, v8, v9
  v_fmamk_f32 v4, v10, 0x42840000, v11
  v_fmamk_f32 v5, v10, 0x42860000, v11
  v_cos_f32 v6, v4
  v_cos_f32 v7, v5
  v_sin_f32_e64 v8, -v4
  v_sin_f32_e64 v9, -v5
  v_cvt_pk_bf16_f32 v25, v6, v7
  v_cvt_pk_bf16_f32 v41, v8, v9
  v_fmamk_f32 v4, v10, 0x42880000, v11
  v_fmamk_f32 v5, v10, 0x428a0000, v11
  v_cos_f32 v6, v4
  v_cos_f32 v7, v5
  v_sin_f32_e64 v8, -v4
  v_sin_f32_e64 v9, -v5
  v_cvt_pk_bf16_f32 v26, v6, v7
  v_cvt_pk_bf16_f32 v42, v8, v9
  v_fmamk_f32 v4, v10, 0x428c0000, v11
  v_fmamk_f32 v5, v10, 0x428e0000, v11
  v_cos_f32 v6, v4
  v_cos_f32 v7, v5
  v_sin_f32_e64 v8, -v4
  v_sin_f32_e64 v9, -v5
  v_cvt_pk_bf16_f32 v27, v6, v7
  v_cvt_pk_bf16_f32 v43, v8, v9
  v_fmamk_f32 v4, v10, 0x42c00000, v11
  v_fmamk_f32 v5, v10, 0x42c20000, v11
  v_cos_f32 v6, v4
  v_cos_f32 v7, v5
  v_sin_f32_e64 v8, -v4
  v_sin_f32_e64 v9, -v5
  v_cvt_pk_bf16_f32 v28, v6, v7
  v_cvt_pk_bf16_f32 v44, v8, v9
  v_fmamk_f32 v4, v10, 0x42c40000, v11
  v_fmamk_f32 v5, v10, 0x42c60000, v11
  v_cos_f32 v6, v4
  v_cos_f32 v7, v5
  v_sin_f32_e64 v8, -v4
  v_sin_f32_e64 v9, -v5
  v_cvt_pk_bf16_f32 v29, v6, v7
  v_cvt_pk_bf16_f32 v45, v8, v9
  v_fmamk_f32 v4, v10, 0x42c80000, v11
  v_fmamk_f32 v5, v10, 0x42ca0000, v11
  v_cos_f32 v6, v4
  v_cos_f32 v7, v5
  v_sin_f32_e64 v8, -v4
  v_sin_f32_e64 v9, -v5
  v_cvt_pk_bf16_f32 v30, v6, v7
  v_cvt_pk_bf16_f32 v46, v8, v9
  v_fmamk_f32 v4, v10, 0x42cc0000, v11
  v_fmamk_f32 v5, v10, 0x42ce0000, v11
  v_cos_f32 v6, v4
  v_cos_f32 v7, v5
  v_sin_f32_e64 v8, -v4
  v_sin_f32_e64 v9, -v5
  v_cvt_pk_bf16_f32 v31, v6, v7
  v_cvt_pk_bf16_f32 v47, v8, v9
  v_add_u32 v10, 0, v2
  v_cvt_f32_u32 v10, v10
  v_mul_f32 v10, 0x3a000000, v10
  v_lshl_add_u32 v11, v3, 8, s43
  v_cvt_f32_u32 v11, v11
  v_mul_f32 v11, v10, v11
  v_mov_b32 v4, v11
  v_fmamk_f32 v5, v10, 0x42800000, v11
  v_cos_f32 v6, v4
  v_cos_f32 v7, v5
  v_sin_f32_e64 v8, -v4
  v_sin_f32_e64 v9, -v5
  v_cvt_pk_bf16_f32 v48, v6, v7
  v_cvt_pk_bf16_f32 v56, v8, v9
  v_xor_b32 v64, s67, v56
  v_fmamk_f32 v4, v10, 0x43000000, v11
  v_fmamk_f32 v5, v10, 0x43400000, v11
  v_cos_f32 v6, v4
  v_cos_f32 v7, v5
  v_sin_f32_e64 v8, -v4
  v_sin_f32_e64 v9, -v5
  v_cvt_pk_bf16_f32 v49, v6, v7
  v_cvt_pk_bf16_f32 v57, v8, v9
  v_xor_b32 v65, s67, v57
  v_fmamk_f32 v4, v10, 0x44800000, v11
  v_fmamk_f32 v5, v10, 0x44880000, v11
  v_cos_f32 v6, v4
  v_cos_f32 v7, v5
  v_sin_f32_e64 v8, -v4
  v_sin_f32_e64 v9, -v5
  v_cvt_pk_bf16_f32 v50, v6, v7
  v_cvt_pk_bf16_f32 v58, v8, v9
  v_xor_b32 v66, s67, v58
  v_fmamk_f32 v4, v10, 0x44900000, v11
  v_fmamk_f32 v5, v10, 0x44980000, v11
  v_cos_f32 v6, v4
  v_cos_f32 v7, v5
  v_sin_f32_e64 v8, -v4
  v_sin_f32_e64 v9, -v5
  v_cvt_pk_bf16_f32 v51, v6, v7
  v_cvt_pk_bf16_f32 v59, v8, v9
  v_xor_b32 v67, s67, v59
  v_add_u32 v10, 16, v2
  v_cvt_f32_u32 v10, v10
  v_mul_f32 v10, 0x3a000000, v10
  v_lshl_add_u32 v11, v3, 8, s43
  v_cvt_f32_u32 v11, v11
  v_mul_f32 v11, v10, v11
  v_mov_b32 v4, v11
  v_fmamk_f32 v5, v10, 0x42800000, v11
  v_cos_f32 v6, v4
  v_cos_f32 v7, v5
  v_sin_f32_e64 v8, -v4
  v_sin_f32_e64 v9, -v5
  v_cvt_pk_bf16_f32 v52, v6, v7
  v_cvt_pk_bf16_f32 v60, v8, v9
  v_xor_b32 v68, s67, v60
  v_fmamk_f32 v4, v10, 0x43000000, v11
  v_fmamk_f32 v5, v10, 0x43400000, v11
  v_cos_f32 v6, v4
  v_cos_f32 v7, v5
  v_sin_f32_e64 v8, -v4
  v_sin_f32_e64 v9, -v5
  v_cvt_pk_bf16_f32 v53, v6, v7
  v_cvt_pk_bf16_f32 v61, v8, v9
  v_xor_b32 v69, s67, v61
  v_fmamk_f32 v4, v10, 0x44800000, v11
  v_fmamk_f32 v5, v10, 0x44880000, v11
  v_cos_f32 v6, v4
  v_cos_f32 v7, v5
  v_sin_f32_e64 v8, -v4
  v_sin_f32_e64 v9, -v5
  v_cvt_pk_bf16_f32 v54, v6, v7
  v_cvt_pk_bf16_f32 v62, v8, v9
  v_xor_b32 v70, s67, v62
  v_fmamk_f32 v4, v10, 0x44900000, v11
  v_fmamk_f32 v5, v10, 0x44980000, v11
  v_cos_f32 v6, v4
  v_cos_f32 v7, v5
  v_sin_f32_e64 v8, -v4
  v_sin_f32_e64 v9, -v5
  v_cvt_pk_bf16_f32 v55, v6, v7
  v_cvt_pk_bf16_f32 v63, v8, v9
  v_xor_b32 v71, s67, v63
  v_mul_u32_u24 v128, 1056, v2
  v_lshl_add_u32 v128, v3, 4, v128
  v_add_u32 v128, 114688, v128
  v_lshrrev_b32 v129, 3, v0
  v_mul_u32_u24 v129, 1056, v129
  v_and_b32 v4, 7, v0
  v_lshl_add_u32 v129, v4, 4, v129
  v_add_u32 v129, 114688, v129
  v_lshrrev_b32 v12, 3, v0
  v_lshlrev_b32 v12, 2, v12
  v_add_u32 v12, 148480, v12
  v_lshlrev_b32 v13, 4, v3
  v_add_u32 v13, 148480, v13
  s_cmp_eq_u32 s2, 0
  s_cselect_b32 s48, s40, 0
  s_cmp_eq_u32 s48, 3
  s_cbranch_scc0 L_NORDY
  s_waitcnt vmcnt(8)
  v_mov_b32 v255, 0
  v_mov_b32 v254, 1
  global_store_dword v255, v254, s[20:21] sc1
  s_nop 0
L_NORDY:
  s_lshr_b32 s48, s2, 2
  s_and_b32 s49, s48, 1
  s_bfe_u32 s50, s48, 0x20001
  s_lshr_b32 s51, s48, 3
  s_and_b32 s52, s2, 3
  s_mul_i32 s52, s52, 7
  s_mul_i32 s53, s50, 458752
  s_lshl_b32 s54, s51, 7
  s_add_u32 s53, s53, s54
  s_lshl_b32 s54, s49, 6
  s_add_u32 s53, s53, s54
  s_add_u32 s54, s52, s40
  s_add_u32 s55, s40, 4
  s_min_u32 s55, s55, 6
  s_add_u32 s55, s55, s52
  v_lshrrev_b32 v176, 2, v1
  v_lshlrev_b32 v176, 10, v176
  v_and_b32 v177, 3, v1
  v_lshl_add_u32 v176, v177, 4, v176
  v_add_u32 v176, s53, v176
  s_lshl_b32 s56, s54, 14
  v_add_u32 v177, s56, v176
  s_add_u32 m0, s70, 0
  s_nop 0
  global_load_lds_dwordx4 v177, s[16:17]
  s_lshl_b32 s56, s55, 14
  v_add_u32 v177, s56, v176
  s_add_u32 m0, s70, 1024
  s_nop 0
  global_load_lds_dwordx4 v177, s[16:17]
  s_mul_i32 s48, s48, 28
  s_add_u32 s10, s48, s54
  s_lshl_b32 s10, s10, 10
  s_add_u32 s10, s10, 0x1200000
  s_add_u32 s11, s48, s55
  s_lshl_b32 s11, s11, 10
  s_add_u32 s11, s11, 0x1200000
  v_mov_b32 v184, -1
  v_mov_b32 v185, -1
  v_mov_b32 v186, -1
  v_mov_b32 v187, -1
  s_lshl_b32 s48, s2, 13
  v_lshl_add_u32 v188, v0, 4, s48
  v_add_u32 v189, 4096, v188
  global_store_dwordx4 v188, v[184:187], s[28:29] sc1
  global_store_dwordx4 v189, v[184:187], s[28:29] sc1
  s_lshl_b32 s48, s2, 9
  v_and_b32 v188, 127, v0
  v_lshl_add_u32 v188, v188, 2, s48
  global_store_dword v188, v184, s[30:31] sc1
  s_mul_i32 s48, s2, 7168
  v_min_u32 v179, 55, v0
  v_lshl_add_u32 v179, v179, 7, s48
  global_load_dword v232, v179, s[12:13]
  s_mul_i32 s48, s2, 4224
  s_bitcmp1_b32 s40, 0
  s_cselect_b32 s50, s8, s6
  s_cselect_b32 s51, s9, s7
  v_min_u32 v180, 32, v1
  v_lshl_add_u32 v180, v180, 7, s48
  v_min_u32 v180, 1052668, v180
  global_load_dword v233, v180, s[50:51]
  s_waitcnt vmcnt(7)
  ds_read_b128 v[72:75], v129 offset:0
  ds_read_b128 v[76:79], v129 offset:128
  ds_read_b128 v[80:83], v129 offset:256
  ds_read_b128 v[84:87], v129 offset:384
  ds_read_b128 v[88:91], v129 offset:512
  ds_read_b128 v[92:95], v129 offset:640
  ds_read_b128 v[96:99], v129 offset:768
  ds_read_b128 v[100:103], v129 offset:896
  v_mov_b32 v130, 0
  v_mov_b32 v131, 0
  s_waitcnt lgkmcnt(7)
  v_dot2c_f32_bf16 v130, s64, v72
  v_dot2c_f32_bf16 v131, v72, v72
  v_dot2c_f32_bf16 v130, s64, v73
  v_dot2c_f32_bf16 v131, v73, v73
  v_dot2c_f32_bf16 v130, s64, v74
  v_dot2c_f32_bf16 v131, v74, v74
  v_dot2c_f32_bf16 v130, s64, v75
  v_dot2c_f32_bf16 v131, v75, v75
  s_waitcnt lgkmcnt(6)
  v_dot2c_f32_bf16 v130, s64, v76
  v_dot2c_f32_bf16 v131, v76, v76
  v_dot2c_f32_bf16 v130, s64, v77
  v_dot2c_f32_bf16 v131, v77, v77
  v_dot2c_f32_bf16 v130, s64, v78
  v_dot2c_f32_bf16 v131, v78, v78
  v_dot2c_f32_bf16 v130, s64, v79
  v_dot2c_f32_bf16 v131, v79, v79
  s_waitcnt lgkmcnt(5)
  v_dot2c_f32_bf16 v130, s64, v80
  v_dot2c_f32_bf16 v131, v80, v80
  v_dot2c_f32_bf16 v130, s64, v81
  v_dot2c_f32_bf16 v131, v81, v81
  v_dot2c_f32_bf16 v130, s64, v82
  v_dot2c_f32_bf16 v131, v82, v82
  v_dot2c_f32_bf16 v130, s64, v83
  v_dot2c_f32_bf16 v131, v83, v83
  s_waitcnt lgkmcnt(4)
  v_dot2c_f32_bf16 v130, s64, v84
  v_dot2c_f32_bf16 v131, v84, v84
  v_dot2c_f32_bf16 v130, s64, v85
  v_dot2c_f32_bf16 v131, v85, v85
  v_dot2c_f32_bf16 v130, s64, v86
  v_dot2c_f32_bf16 v131, v86, v86
  v_dot2c_f32_bf16 v130, s64, v87
  v_dot2c_f32_bf16 v131, v87, v87
  s_waitcnt lgkmcnt(3)
  v_dot2c_f32_bf16 v130, s64, v88
  v_dot2c_f32_bf16 v131, v88, v88
  v_dot2c_f32_bf16 v130, s64, v89
  v_dot2c_f32_bf16 v131, v89, v89
  v_dot2c_f32_bf16 v130, s64, v90
  v_dot2c_f32_bf16 v131, v90, v90
  v_dot2c_f32_bf16 v130, s64, v91
  v_dot2c_f32_bf16 v131, v91, v91
  s_waitcnt lgkmcnt(2)
  v_dot2c_f32_bf16 v130, s64, v92
  v_dot2c_f32_bf16 v131, v92, v92
  v_dot2c_f32_bf16 v130, s64, v93
  v_dot2c_f32_bf16 v131, v93, v93
  v_dot2c_f32_bf16 v130, s64, v94
  v_dot2c_f32_bf16 v131, v94, v94
  v_dot2c_f32_bf16 v130, s64, v95
  v_dot2c_f32_bf16 v131, v95, v95
  s_waitcnt lgkmcnt(1)
  v_dot2c_f32_bf16 v130, s64, v96
  v_dot2c_f32_bf16 v131, v96, v96
  v_dot2c_f32_bf16 v130, s64, v97
  v_dot2c_f32_bf16 v131, v97, v97
  v_dot2c_f32_bf16 v130, s64, v98
  v_dot2c_f32_bf16 v131, v98, v98
  v_dot2c_f32_bf16 v130, s64, v99
  v_dot2c_f32_bf16 v131, v99, v99
  s_waitcnt lgkmcnt(0)
  v_dot2c_f32_bf16 v130, s64, v100
  v_dot2c_f32_bf16 v131, v100, v100
  v_dot2c_f32_bf16 v130, s64, v101
  v_dot2c_f32_bf16 v131, v101, v101
  v_dot2c_f32_bf16 v130, s64, v102
  v_dot2c_f32_bf16 v131, v102, v102
  v_dot2c_f32_bf16 v130, s64, v103
  v_dot2c_f32_bf16 v131, v103, v103
  s_nop 1
  v_add_f32_dpp v130, v130, v130 quad_perm:[1,0,3,2] row_mask:0xf bank_mask:0xf
  v_add_f32_dpp v131, v131, v131 quad_perm:[1,0,3,2] row_mask:0xf bank_mask:0xf
  s_nop 0
  v_add_f32_dpp v130, v130, v130 quad_perm:[2,3,0,1] row_mask:0xf bank_mask:0xf
  v_add_f32_dpp v131, v131, v131 quad_perm:[2,3,0,1] row_mask:0xf bank_mask:0xf
  s_nop 0
  v_add_f32_dpp v130, v130, v130 row_half_mirror row_mask:0xf bank_mask:0xf
  v_add_f32_dpp v131, v131, v131 row_half_mirror row_mask:0xf bank_mask:0xf
  v_mul_f32 v4, 0x3b000000, v130
  v_mul_f32 v6, 0x3b000000, v131
  v_fma_f32 v6, -v4, v4, v6
  v_max_f32 v6, 0, v6
  v_cvt_pk_bf16_f32 v7, v6, v6
  v_lshlrev_b32 v6, 16, v7
  v_add_f32 v6, 0x3727c5ac, v6
  v_cvt_pk_bf16_f32 v7, v6, v6
  v_lshlrev_b32 v6, 16, v7
  v_sqrt_f32 v6, v6
  s_nop 0
  v_cvt_pk_bf16_f32 v7, v6, v6
  v_lshlrev_b32 v6, 16, v7
  v_rcp_f32 v5, v6
  v_cvt_pk_bf16_f32 v7, v4, v4
  v_lshlrev_b32 v4, 16, v7
  ds_write_b32 v12, v5
  s_waitcnt lgkmcnt(0)
  s_barrier
  ds_read_b128 v[132:135], v13 offset:0
  ds_read_b128 v[136:139], v13 offset:64
  s_cmp_eq_u32 s40, 1
  s_cbranch_scc1 P1_C1
  s_cmp_eq_u32 s40, 2
  s_cbranch_scc1 P1_C2
  s_cmp_eq_u32 s40, 3
  s_cbranch_scc1 P1_C3
P1_C0:
  ds_read_b128 v[104:107], v128 offset:0
  ds_read_b128 v[108:111], v128 offset:16896
  ds_read_b128 v[112:115], v128 offset:64
  ds_read_b128 v[116:119], v128 offset:16960
  ds_read_b128 v[120:123], v128 offset:128
  s_waitcnt lgkmcnt(4)
  v_mfma_f32_16x16x32_bf16 v[72:75], v[104:107], v[16:19], 0
  ds_read_b128 v[124:127], v128 offset:17024
  v_mfma_f32_16x16x32_bf16 v[80:83], v[104:107], v[32:35], 0
  s_waitcnt lgkmcnt(4)
  v_mfma_f32_16x16x32_bf16 v[88:91], v[108:111], v[16:19], 0
  ds_read_b128 v[104:107], v128 offset:192
  v_mfma_f32_16x16x32_bf16 v[96:99], v[108:111], v[32:35], 0
  s_waitcnt lgkmcnt(4)
  v_mfma_f32_16x16x32_bf16 v[72:75], v[112:115], v[20:23], v[72:75]
  ds_read_b128 v[108:111], v128 offset:17088
  v_mfma_f32_16x16x32_bf16 v[80:83], v[112:115], v[36:39], v[80:83]
  s_waitcnt lgkmcnt(4)
  v_mfma_f32_16x16x32_bf16 v[88:91], v[116:119], v[20:23], v[88:91]
  ds_read_b128 v[112:115], v128 offset:256
  v_mfma_f32_16x16x32_bf16 v[96:99], v[116:119], v[36:39], v[96:99]
  s_waitcnt lgkmcnt(4)
  v_mfma_f32_16x16x32_bf16 v[72:75], v[120:123], v[24:27], v[72:75]
  ds_read_b128 v[116:119], v128 offset:17152
  v_mfma_f32_16x16x32_bf16 v[80:83], v[120:123], v[40:43], v[80:83]
  s_waitcnt lgkmcnt(4)
  v_mfma_f32_16x16x32_bf16 v[88:91], v[124:127], v[24:27], v[88:91]
  ds_read_b128 v[120:123], v128 offset:320
  v_mfma_f32_16x16x32_bf16 v[96:99], v[124:127], v[40:43], v[96:99]
  s_waitcnt lgkmcnt(4)
  v_mfma_f32_16x16x32_bf16 v[72:75], v[104:107], v[28:31], v[72:75]
  ds_read_b128 v[124:127], v128 offset:17216
  v_mfma_f32_16x16x32_bf16 v[80:83], v[104:107], v[44:47], v[80:83]
  s_waitcnt lgkmcnt(4)
  v_mfma_f32_16x16x32_bf16 v[88:91], v[108:111], v[28:31], v[88:91]
  ds_read_b128 v[104:107], v128 offset:384
  v_mfma_f32_16x16x32_bf16 v[96:99], v[108:111], v[44:47], v[96:99]
  s_waitcnt lgkmcnt(4)
  v_mfma_f32_16x16x32_bf16 v[72:75], v[112:115], v[16:19], v[72:75]
  ds_read_b128 v[108:111], v128 offset:17280
  v_mfma_f32_16x16x32_bf16 v[80:83], v[112:115], v[32:35], v[80:83]
  s_waitcnt lgkmcnt(4)
  v_mfma_f32_16x16x32_bf16 v[88:91], v[116:119], v[16:19], v[88:91]
  ds_read_b128 v[112:115], v128 offset:448
  v_mfma_f32_16x16x32_bf16 v[96:99], v[116:119], v[32:35], v[96:99]
  s_waitcnt lgkmcnt(4)
  v_mfma_f32_16x16x32_bf16 v[72:75], v[120:123], v[20:23], v[72:75]
  ds_read_b128 v[116:119], v128 offset:17344
  v_mfma_f32_16x16x32_bf16 v[80:83], v[120:123], v[36:39], v[80:83]
  s_waitcnt lgkmcnt(4)
  v_mfma_f32_16x16x32_bf16 v[88:91], v[124:127], v[20:23], v[88:91]
  ds_read_b128 v[120:123], v128 offset:512
  v_mfma_f32_16x16x32_bf16 v[96:99], v[124:127], v[36:39], v[96:99]
  s_waitcnt lgkmcnt(4)
  v_mfma_f32_16x16x32_bf16 v[72:75], v[104:107], v[24:27], v[72:75]
  ds_read_b128 v[124:127], v128 offset:17408
  v_mfma_f32_16x16x32_bf16 v[80:83], v[104:107], v[40:43], v[80:83]
  s_waitcnt lgkmcnt(4)
  v_mfma_f32_16x16x32_bf16 v[88:91], v[108:111], v[24:27], v[88:91]
  ds_read_b128 v[104:107], v128 offset:576
  v_mfma_f32_16x16x32_bf16 v[96:99], v[108:111], v[40:43], v[96:99]
  s_waitcnt lgkmcnt(4)
  v_mfma_f32_16x16x32_bf16 v[72:75], v[112:115], v[28:31], v[72:75]
  ds_read_b128 v[108:111], v128 offset:17472
  v_mfma_f32_16x16x32_bf16 v[80:83], v[112:115], v[44:47], v[80:83]
  s_waitcnt lgkmcnt(4)
  v_mfma_f32_16x16x32_bf16 v[88:91], v[116:119], v[28:31], v[88:91]
  ds_read_b128 v[112:115], v128 offset:640
  v_mfma_f32_16x16x32_bf16 v[96:99], v[116:119], v[44:47], v[96:99]
  s_waitcnt lgkmcnt(4)
  v_mfma_f32_16x16x32_bf16 v[72:75], v[120:123], v[16:19], v[72:75]
  ds_read_b128 v[116:119], v128 offset:17536
  v_mfma_f32_16x16x32_bf16 v[80:83], v[120:123], v[32:35], v[80:83]
  s_waitcnt lgkmcnt(4)
  v_mfma_f32_16x16x32_bf16 v[88:91], v[124:127], v[16:19], v[88:91]
  ds_read_b128 v[120:123], v128 offset:704
  v_mfma_f32_16x16x32_bf16 v[96:99], v[124:127], v[32:35], v[96:99]
  s_waitcnt lgkmcnt(4)
  v_mfma_f32_16x16x32_bf16 v[72:75], v[104:107], v[20:23], v[72:75]
  ds_read_b128 v[124:127], v128 offset:17600
  v_mfma_f32_16x16x32_bf16 v[80:83], v[104:107], v[36:39], v[80:83]
  s_waitcnt lgkmcnt(4)
  v_mfma_f32_16x16x32_bf16 v[88:91], v[108:111], v[20:23], v[88:91]
  ds_read_b128 v[104:107], v128 offset:768
  v_mfma_f32_16x16x32_bf16 v[96:99], v[108:111], v[36:39], v[96:99]
  s_waitcnt lgkmcnt(4)
  v_mfma_f32_16x16x32_bf16 v[72:75], v[112:115], v[24:27], v[72:75]
  ds_read_b128 v[108:111], v128 offset:17664
  v_mfma_f32_16x16x32_bf16 v[80:83], v[112:115], v[40:43], v[80:83]
  s_waitcnt lgkmcnt(4)
  v_mfma_f32_16x16x32_bf16 v[88:91], v[116:119], v[24:27], v[88:91]
  ds_read_b128 v[112:115], v128 offset:832
  v_mfma_f32_16x16x32_bf16 v[96:99], v[116:119], v[40:43], v[96:99]
  s_waitcnt lgkmcnt(4)
  v_mfma_f32_16x16x32_bf16 v[72:75], v[120:123], v[28:31], v[72:75]
  ds_read_b128 v[116:119], v128 offset:17728
  v_mfma_f32_16x16x32_bf16 v[80:83], v[120:123], v[44:47], v[80:83]
  s_waitcnt lgkmcnt(4)
  v_mfma_f32_16x16x32_bf16 v[88:91], v[124:127], v[28:31], v[88:91]
  ds_read_b128 v[120:123], v128 offset:896
  v_mfma_f32_16x16x32_bf16 v[96:99], v[124:127], v[44:47], v[96:99]
  s_waitcnt lgkmcnt(4)
  v_mfma_f32_16x16x32_bf16 v[72:75], v[104:107], v[16:19], v[72:75]
  ds_read_b128 v[124:127], v128 offset:17792
  v_mfma_f32_16x16x32_bf16 v[80:83], v[104:107], v[32:35], v[80:83]
  s_waitcnt lgkmcnt(4)
  v_mfma_f32_16x16x32_bf16 v[88:91], v[108:111], v[16:19], v[88:91]
  ds_read_b128 v[104:107], v128 offset:960
  v_mfma_f32_16x16x32_bf16 v[96:99], v[108:111], v[32:35], v[96:99]
  s_waitcnt lgkmcnt(4)
  v_mfma_f32_16x16x32_bf16 v[72:75], v[112:115], v[20:23], v[72:75]
  ds_read_b128 v[108:111], v128 offset:17856
  v_mfma_f32_16x16x32_bf16 v[80:83], v[112:115], v[36:39], v[80:83]
  s_waitcnt lgkmcnt(4)
  v_mfma_f32_16x16x32_bf16 v[88:91], v[116:119], v[20:23], v[88:91]
  v_mfma_f32_16x16x32_bf16 v[96:99], v[116:119], v[36:39], v[96:99]
  s_waitcnt lgkmcnt(3)
  v_mfma_f32_16x16x32_bf16 v[72:75], v[120:123], v[24:27], v[72:75]
  v_mfma_f32_16x16x32_bf16 v[80:83], v[120:123], v[40:43], v[80:83]
  s_waitcnt lgkmcnt(2)
  v_mfma_f32_16x16x32_bf16 v[88:91], v[124:127], v[24:27], v[88:91]
  v_mfma_f32_16x16x32_bf16 v[96:99], v[124:127], v[40:43], v[96:99]
  s_waitcnt lgkmcnt(1)
  v_mfma_f32_16x16x32_bf16 v[72:75], v[104:107], v[28:31], v[72:75]
  v_mfma_f32_16x16x32_bf16 v[80:83], v[104:107], v[44:47], v[80:83]
  s_waitcnt lgkmcnt(0)
  v_mfma_f32_16x16x32_bf16 v[88:91], v[108:111], v[28:31], v[88:91]
  v_mfma_f32_16x16x32_bf16 v[96:99], v[108:111], v[44:47], v[96:99]
  s_nop 3
  v_mul_f32 v72, v72, v132
  v_mul_f32 v73, v73, v133
  v_mul_f32 v74, v74, v134
  v_mul_f32 v75, v75, v135
  v_cvt_pk_bf16_f32 v104, v72, v73
  v_cvt_pk_bf16_f32 v105, v74, v75
  v_mul_f32 v88, v88, v136
  v_mul_f32 v89, v89, v137
  v_mul_f32 v90, v90, v138
  v_mul_f32 v91, v91, v139
  v_cvt_pk_bf16_f32 v106, v88, v89
  v_cvt_pk_bf16_f32 v107, v90, v91
  v_mul_f32 v80, v80, v132
  v_mul_f32 v81, v81, v133
  v_mul_f32 v82, v82, v134
  v_mul_f32 v83, v83, v135
  v_cvt_pk_bf16_f32 v108, v80, v81
  v_cvt_pk_bf16_f32 v109, v82, v83
  v_mul_f32 v96, v96, v136
  v_mul_f32 v97, v97, v137
  v_mul_f32 v98, v98, v138
  v_mul_f32 v99, v99, v139
  v_cvt_pk_bf16_f32 v110, v96, v97
  v_cvt_pk_bf16_f32 v111, v98, v99
  s_nop 1
  s_branch P1_JOIN
P1_C1:
  ds_read_b128 v[104:107], v128 offset:0
  ds_read_b128 v[108:111], v128 offset:16896
  ds_read_b128 v[112:115], v128 offset:64
  ds_read_b128 v[116:119], v128 offset:16960
  ds_read_b128 v[120:123], v128 offset:128
  s_waitcnt lgkmcnt(4)
  v_mfma_f32_16x16x32_bf16 v[72:75], v[104:107], v[16:19], 0
  ds_read_b128 v[124:127], v128 offset:17024
  v_mfma_f32_16x16x32_bf16 v[80:83], v[104:107], v[32:35], 0
  s_waitcnt lgkmcnt(4)
  v_mfma_f32_16x16x32_bf16 v[88:91], v[108:111], v[16:19], 0
  ds_read_b128 v[104:107], v128 offset:192
  v_mfma_f32_16x16x32_bf16 v[96:99], v[108:111], v[32:35], 0
  s_waitcnt lgkmcnt(4)
  v_mfma_f32_16x16x32_bf16 v[72:75], v[112:115], v[20:23], v[72:75]
  ds_read_b128 v[108:111], v128 offset:17088
  v_mfma_f32_16x16x32_bf16 v[80:83], v[112:115], v[36:39], v[80:83]
  s_waitcnt lgkmcnt(4)
  v_mfma_f32_16x16x32_bf16 v[88:91], v[116:119], v[20:23], v[88:91]
  ds_read_b128 v[112:115], v128 offset:256
  v_mfma_f32_16x16x32_bf16 v[96:99], v[116:119], v[36:39], v[96:99]
  s_waitcnt lgkmcnt(4)
  v_mfma_f32_16x16x32_bf16 v[72:75], v[120:123], v[24:27], v[72:75]
  ds_read_b128 v[116:119], v128 offset:17152
  v_mfma_f32_16x16x32_bf16 v[80:83], v[120:123], v[40:43], v[80:83]
  s_waitcnt lgkmcnt(4)
  v_mfma_f32_16x16x32_bf16 v[88:91], v[124:127], v[24:27], v[88:91]
  ds_read_b128 v[120:123], v128 offset:320
  v_mfma_f32_16x16x32_bf16 v[96:99], v[124:127], v[40:43], v[96:99]
  s_waitcnt lgkmcnt(4)
  v_mfma_f32_16x16x32_bf16 v[72:75], v[104:107], v[28:31], v[72:75]
  ds_read_b128 v[124:127], v128 offset:17216
  v_mfma_f32_16x16x32_bf16 v[80:83], v[104:107], v[44:47], v[80:83]
  s_waitcnt lgkmcnt(4)
  v_mfma_f32_16x16x32_bf16 v[88:91], v[108:111], v[28:31], v[88:91]
  ds_read_b128 v[104:107], v128 offset:384
  v_mfma_f32_16x16x32_bf16 v[96:99], v[108:111], v[44:47], v[96:99]
  s_waitcnt lgkmcnt(4)
  v_mfma_f32_16x16x32_bf16 v[84:87], v[112:115], v[16:19], 0
  ds_read_b128 v[108:111], v128 offset:17280
  v_mfma_f32_16x16x32_bf16 v[72:75], v[112:115], v[32:35], v[72:75]
  s_waitcnt lgkmcnt(4)
  v_mfma_f32_16x16x32_bf16 v[100:103], v[116:119], v[16:19], 0
  ds_read_b128 v[112:115], v128 offset:448
  v_mfma_f32_16x16x32_bf16 v[88:91], v[116:119], v[32:35], v[88:91]
  s_waitcnt lgkmcnt(4)
  v_mfma_f32_16x16x32_bf16 v[84:87], v[120:123], v[20:23], v[84:87]
  ds_read_b128 v[116:119], v128 offset:17344
  v_mfma_f32_16x16x32_bf16 v[72:75], v[120:123], v[36:39], v[72:75]
  s_waitcnt lgkmcnt(4)
  v_mfma_f32_16x16x32_bf16 v[100:103], v[124:127], v[20:23], v[100:103]
  ds_read_b128 v[120:123], v128 offset:512
  v_mfma_f32_16x16x32_bf16 v[88:91], v[124:127], v[36:39], v[88:91]
  s_waitcnt lgkmcnt(4)
  v_mfma_f32_16x16x32_bf16 v[84:87], v[104:107], v[24:27], v[84:87]
  ds_read_b128 v[124:127], v128 offset:17408
  v_mfma_f32_16x16x32_bf16 v[72:75], v[104:107], v[40:43], v[72:75]
  s_waitcnt lgkmcnt(4)
  v_mfma_f32_16x16x32_bf16 v[100:103], v[108:111], v[24:27], v[100:103]
  ds_read_b128 v[104:107], v128 offset:576
  v_mfma_f32_16x16x32_bf16 v[88:91], v[108:111], v[40:43], v[88:91]
  s_waitcnt lgkmcnt(4)
  v_mfma_f32_16x16x32_bf16 v[84:87], v[112:115], v[28:31], v[84:87]
  ds_read_b128 v[108:111], v128 offset:17472
  v_mfma_f32_16x16x32_bf16 v[72:75], v[112:115], v[44:47], v[72:75]
  s_waitcnt lgkmcnt(4)
  v_mfma_f32_16x16x32_bf16 v[100:103], v[116:119], v[28:31], v[100:103]
  ds_read_b128 v[112:115], v128 offset:640
  v_mfma_f32_16x16x32_bf16 v[88:91], v[116:119], v[44:47], v[88:91]
  s_waitcnt lgkmcnt(4)
  v_mfma_f32_16x16x32_bf16 v[76:79], v[120:123], v[16:19], 0
  ds_read_b128 v[116:119], v128 offset:17536
  v_mfma_f32_16x16x32_bf16 v[84:87], v[120:123], v[32:35], v[84:87]
  s_waitcnt lgkmcnt(4)
  v_mfma_f32_16x16x32_bf16 v[92:95], v[124:127], v[16:19], 0
  ds_read_b128 v[120:123], v128 offset:704
  v_mfma_f32_16x16x32_bf16 v[100:103], v[124:127], v[32:35], v[100:103]
  s_waitcnt lgkmcnt(4)
  v_mfma_f32_16x16x32_bf16 v[76:79], v[104:107], v[20:23], v[76:79]
  ds_read_b128 v[124:127], v128 offset:17600
  v_mfma_f32_16x16x32_bf16 v[84:87], v[104:107], v[36:39], v[84:87]
  s_waitcnt lgkmcnt(4)
  v_mfma_f32_16x16x32_bf16 v[92:95], v[108:111], v[20:23], v[92:95]
  ds_read_b128 v[104:107], v128 offset:768
  v_mfma_f32_16x16x32_bf16 v[100:103], v[108:111], v[36:39], v[100:103]
  s_waitcnt lgkmcnt(4)
  v_mfma_f32_16x16x32_bf16 v[76:79], v[112:115], v[24:27], v[76:79]
  ds_read_b128 v[108:111], v128 offset:17664
  v_mfma_f32_16x16x32_bf16 v[84:87], v[112:115], v[40:43], v[84:87]
  s_waitcnt lgkmcnt(4)
  v_mfma_f32_16x16x32_bf16 v[92:95], v[116:119], v[24:27], v[92:95]
  ds_read_b128 v[112:115], v128 offset:832
  v_mfma_f32_16x16x32_bf16 v[100:103], v[116:119], v[40:43], v[100:103]
  s_waitcnt lgkmcnt(4)
  v_mfma_f32_16x16x32_bf16 v[76:79], v[120:123], v[28:31], v[76:79]
  ds_read_b128 v[116:119], v128 offset:17728
  v_mfma_f32_16x16x32_bf16 v[84:87], v[120:123], v[44:47], v[84:87]
  s_waitcnt lgkmcnt(4)
  v_mfma_f32_16x16x32_bf16 v[92:95], v[124:127], v[28:31], v[92:95]
  ds_read_b128 v[120:123], v128 offset:896
  v_mfma_f32_16x16x32_bf16 v[100:103], v[124:127], v[44:47], v[100:103]
  s_waitcnt lgkmcnt(4)
  v_mfma_f32_16x16x32_bf16 v[80:83], v[104:107], v[16:19], v[80:83]
  ds_read_b128 v[124:127], v128 offset:17792
  v_mfma_f32_16x16x32_bf16 v[76:79], v[104:107], v[32:35], v[76:79]
  s_waitcnt lgkmcnt(4)
  v_mfma_f32_16x16x32_bf16 v[96:99], v[108:111], v[16:19], v[96:99]
  ds_read_b128 v[104:107], v128 offset:960
  v_mfma_f32_16x16x32_bf16 v[92:95], v[108:111], v[32:35], v[92:95]
  s_waitcnt lgkmcnt(4)
  v_mfma_f32_16x16x32_bf16 v[80:83], v[112:115], v[20:23], v[80:83]
  ds_read_b128 v[108:111], v128 offset:17856
  v_mfma_f32_16x16x32_bf16 v[76:79], v[112:115], v[36:39], v[76:79]
  s_waitcnt lgkmcnt(4)
  v_mfma_f32_16x16x32_bf16 v[96:99], v[116:119], v[20:23], v[96:99]
  v_mfma_f32_16x16x32_bf16 v[92:95], v[116:119], v[36:39], v[92:95]
  s_waitcnt lgkmcnt(3)
  v_mfma_f32_16x16x32_bf16 v[80:83], v[120:123], v[24:27], v[80:83]
  v_mfma_f32_16x16x32_bf16 v[76:79], v[120:123], v[40:43], v[76:79]
  s_waitcnt lgkmcnt(2)
  v_mfma_f32_16x16x32_bf16 v[96:99], v[124:127], v[24:27], v[96:99]
  v_mfma_f32_16x16x32_bf16 v[92:95], v[124:127], v[40:43], v[92:95]
  s_waitcnt lgkmcnt(1)
  v_mfma_f32_16x16x32_bf16 v[80:83], v[104:107], v[28:31], v[80:83]
  v_mfma_f32_16x16x32_bf16 v[76:79], v[104:107], v[44:47], v[76:79]
  s_waitcnt lgkmcnt(0)
  v_mfma_f32_16x16x32_bf16 v[96:99], v[108:111], v[28:31], v[96:99]
  v_mfma_f32_16x16x32_bf16 v[92:95], v[108:111], v[44:47], v[92:95]
  s_nop 4
  v_sub_f32 v72, v72, v76
  v_sub_f32 v73, v73, v77
  v_sub_f32 v74, v74, v78
  v_sub_f32 v75, v75, v79
  v_sub_f32 v88, v88, v92
  v_sub_f32 v89, v89, v93
  v_sub_f32 v90, v90, v94
  v_sub_f32 v91, v91, v95
  v_sub_f32 v80, v80, v84
  v_sub_f32 v81, v81, v85
  v_sub_f32 v82, v82, v86
  v_sub_f32 v83, v83, v87
  v_sub_f32 v96, v96, v100
  v_sub_f32 v97, v97, v101
  v_sub_f32 v98, v98, v102
  v_sub_f32 v99, v99, v103
  v_mul_f32 v72, v72, v132
  v_mul_f32 v73, v73, v133
  v_mul_f32 v74, v74, v134
  v_mul_f32 v75, v75, v135
  v_cvt_pk_bf16_f32 v104, v72, v73
  v_cvt_pk_bf16_f32 v105, v74, v75
  v_mul_f32 v88, v88, v136
  v_mul_f32 v89, v89, v137
  v_mul_f32 v90, v90, v138
  v_mul_f32 v91, v91, v139
  v_cvt_pk_bf16_f32 v106, v88, v89
  v_cvt_pk_bf16_f32 v107, v90, v91
  v_mul_f32 v80, v80, v132
  v_mul_f32 v81, v81, v133
  v_mul_f32 v82, v82, v134
  v_mul_f32 v83, v83, v135
  v_cvt_pk_bf16_f32 v108, v80, v81
  v_cvt_pk_bf16_f32 v109, v82, v83
  v_mul_f32 v96, v96, v136
  v_mul_f32 v97, v97, v137
  v_mul_f32 v98, v98, v138
  v_mul_f32 v99, v99, v139
  v_cvt_pk_bf16_f32 v110, v96, v97
  v_cvt_pk_bf16_f32 v111, v98, v99
  s_nop 1
  s_branch P1_JOIN
P1_C2:
  ds_read_b128 v[104:107], v128 offset:0
  ds_read_b128 v[108:111], v128 offset:16896
  ds_read_b128 v[112:115], v128 offset:64
  ds_read_b128 v[116:119], v128 offset:16960
  ds_read_b128 v[120:123], v128 offset:128
  s_waitcnt lgkmcnt(4)
  v_mfma_f32_16x16x32_bf16 v[72:75], v[104:107], v[16:19], 0
  ds_read_b128 v[124:127], v128 offset:17024
  v_mfma_f32_16x16x32_bf16 v[80:83], v[104:107], v[32:35], 0
  s_waitcnt lgkmcnt(4)
  v_mfma_f32_16x16x32_bf16 v[88:91], v[108:111], v[16:19], 0
  ds_read_b128 v[104:107], v128 offset:192
  v_mfma_f32_16x16x32_bf16 v[96:99], v[108:111], v[32:35], 0
  s_waitcnt lgkmcnt(4)
  v_mfma_f32_16x16x32_bf16 v[72:75], v[112:115], v[20:23], v[72:75]
  ds_read_b128 v[108:111], v128 offset:17088
  v_mfma_f32_16x16x32_bf16 v[80:83], v[112:115], v[36:39], v[80:83]
  s_waitcnt lgkmcnt(4)
  v_mfma_f32_16x16x32_bf16 v[88:91], v[116:119], v[20:23], v[88:91]
  ds_read_b128 v[112:115], v128 offset:256
  v_mfma_f32_16x16x32_bf16 v[96:99], v[116:119], v[36:39], v[96:99]
  s_waitcnt lgkmcnt(4)
  v_mfma_f32_16x16x32_bf16 v[72:75], v[120:123], v[24:27], v[72:75]
  ds_read_b128 v[116:119], v128 offset:17152
  v_mfma_f32_16x16x32_bf16 v[80:83], v[120:123], v[40:43], v[80:83]
  s_waitcnt lgkmcnt(4)
  v_mfma_f32_16x16x32_bf16 v[88:91], v[124:127], v[24:27], v[88:91]
  ds_read_b128 v[120:123], v128 offset:320
  v_mfma_f32_16x16x32_bf16 v[96:99], v[124:127], v[40:43], v[96:99]
  s_waitcnt lgkmcnt(4)
  v_mfma_f32_16x16x32_bf16 v[72:75], v[104:107], v[28:31], v[72:75]
  ds_read_b128 v[124:127], v128 offset:17216
  v_mfma_f32_16x16x32_bf16 v[80:83], v[104:107], v[44:47], v[80:83]
  s_waitcnt lgkmcnt(4)
  v_mfma_f32_16x16x32_bf16 v[88:91], v[108:111], v[28:31], v[88:91]
  ds_read_b128 v[104:107], v128 offset:384
  v_mfma_f32_16x16x32_bf16 v[96:99], v[108:111], v[44:47], v[96:99]
  s_waitcnt lgkmcnt(4)
  v_mfma_f32_16x16x32_bf16 v[76:79], v[112:115], v[16:19], 0
  ds_read_b128 v[108:111], v128 offset:17280
  v_mfma_f32_16x16x32_bf16 v[84:87], v[112:115], v[32:35], 0
  s_waitcnt lgkmcnt(4)
  v_mfma_f32_16x16x32_bf16 v[92:95], v[116:119], v[16:19], 0
  ds_read_b128 v[112:115], v128 offset:448
  v_mfma_f32_16x16x32_bf16 v[100:103], v[116:119], v[32:35], 0
  s_waitcnt lgkmcnt(4)
  v_mfma_f32_16x16x32_bf16 v[76:79], v[120:123], v[20:23], v[76:79]
  ds_read_b128 v[116:119], v128 offset:17344
  v_mfma_f32_16x16x32_bf16 v[84:87], v[120:123], v[36:39], v[84:87]
  s_waitcnt lgkmcnt(4)
  v_mfma_f32_16x16x32_bf16 v[92:95], v[124:127], v[20:23], v[92:95]
  ds_read_b128 v[120:123], v128 offset:512
  v_mfma_f32_16x16x32_bf16 v[100:103], v[124:127], v[36:39], v[100:103]
  s_waitcnt lgkmcnt(4)
  v_mfma_f32_16x16x32_bf16 v[76:79], v[104:107], v[24:27], v[76:79]
  ds_read_b128 v[124:127], v128 offset:17408
  v_mfma_f32_16x16x32_bf16 v[84:87], v[104:107], v[40:43], v[84:87]
  s_waitcnt lgkmcnt(4)
  v_mfma_f32_16x16x32_bf16 v[92:95], v[108:111], v[24:27], v[92:95]
  ds_read_b128 v[104:107], v128 offset:576
  v_mfma_f32_16x16x32_bf16 v[100:103], v[108:111], v[40:43], v[100:103]
  s_waitcnt lgkmcnt(4)
  v_mfma_f32_16x16x32_bf16 v[76:79], v[112:115], v[28:31], v[76:79]
  ds_read_b128 v[108:111], v128 offset:17472
  v_mfma_f32_16x16x32_bf16 v[84:87], v[112:115], v[44:47], v[84:87]
  s_waitcnt lgkmcnt(4)
  v_mfma_f32_16x16x32_bf16 v[92:95], v[116:119], v[28:31], v[92:95]
  ds_read_b128 v[112:115], v128 offset:640
  v_mfma_f32_16x16x32_bf16 v[100:103], v[116:119], v[44:47], v[100:103]
  s_waitcnt lgkmcnt(4)
  v_mfma_f32_16x16x32_bf16 v[72:75], v[120:123], v[16:19], v[72:75]
  ds_read_b128 v[116:119], v128 offset:17536
  v_mfma_f32_16x16x32_bf16 v[80:83], v[120:123], v[32:35], v[80:83]
  s_waitcnt lgkmcnt(4)
  v_mfma_f32_16x16x32_bf16 v[88:91], v[124:127], v[16:19], v[88:91]
  ds_read_b128 v[120:123], v128 offset:704
  v_mfma_f32_16x16x32_bf16 v[96:99], v[124:127], v[32:35], v[96:99]
  s_waitcnt lgkmcnt(4)
  v_mfma_f32_16x16x32_bf16 v[72:75], v[104:107], v[20:23], v[72:75]
  ds_read_b128 v[124:127], v128 offset:17600
  v_mfma_f32_16x16x32_bf16 v[80:83], v[104:107], v[36:39], v[80:83]
  s_waitcnt lgkmcnt(4)
  v_mfma_f32_16x16x32_bf16 v[88:91], v[108:111], v[20:23], v[88:91]
  ds_read_b128 v[104:107], v128 offset:768
  v_mfma_f32_16x16x32_bf16 v[96:99], v[108:111], v[36:39], v[96:99]
  s_waitcnt lgkmcnt(4)
  v_mfma_f32_16x16x32_bf16 v[72:75], v[112:115], v[24:27], v[72:75]
  ds_read_b128 v[108:111], v128 offset:17664
  v_mfma_f32_16x16x32_bf16 v[80:83], v[112:115], v[40:43], v[80:83]
  s_waitcnt lgkmcnt(4)
  v_mfma_f32_16x16x32_bf16 v[88:91], v[116:119], v[24:27], v[88:91]
  ds_read_b128 v[112:115], v128 offset:832
  v_mfma_f32_16x16x32_bf16 v[96:99], v[116:119], v[40:43], v[96:99]
  s_waitcnt lgkmcnt(4)
  v_mfma_f32_16x16x32_bf16 v[72:75], v[120:123], v[28:31], v[72:75]
  ds_read_b128 v[116:119], v128 offset:17728
  v_mfma_f32_16x16x32_bf16 v[80:83], v[120:123], v[44:47], v[80:83]
  s_waitcnt lgkmcnt(4)
  v_mfma_f32_16x16x32_bf16 v[88:91], v[124:127], v[28:31], v[88:91]
  ds_read_b128 v[120:123], v128 offset:896
  v_mfma_f32_16x16x32_bf16 v[96:99], v[124:127], v[44:47], v[96:99]
  s_waitcnt lgkmcnt(4)
  v_mfma_f32_16x16x32_bf16 v[76:79], v[104:107], v[16:19], v[76:79]
  ds_read_b128 v[124:127], v128 offset:17792
  v_mfma_f32_16x16x32_bf16 v[84:87], v[104:107], v[32:35], v[84:87]
  s_waitcnt lgkmcnt(4)
  v_mfma_f32_16x16x32_bf16 v[92:95], v[108:111], v[16:19], v[92:95]
  ds_read_b128 v[104:107], v128 offset:960
  v_mfma_f32_16x16x32_bf16 v[100:103], v[108:111], v[32:35], v[100:103]
  s_waitcnt lgkmcnt(4)
  v_mfma_f32_16x16x32_bf16 v[76:79], v[112:115], v[20:23], v[76:79]
  ds_read_b128 v[108:111], v128 offset:17856
  v_mfma_f32_16x16x32_bf16 v[84:87], v[112:115], v[36:39], v[84:87]
  s_waitcnt lgkmcnt(4)
  v_mfma_f32_16x16x32_bf16 v[92:95], v[116:119], v[20:23], v[92:95]
  v_mfma_f32_16x16x32_bf16 v[100:103], v[116:119], v[36:39], v[100:103]
  s_waitcnt lgkmcnt(3)
  v_mfma_f32_16x16x32_bf16 v[76:79], v[120:123], v[24:27], v[76:79]
  v_mfma_f32_16x16x32_bf16 v[84:87], v[120:123], v[40:43], v[84:87]
  s_waitcnt lgkmcnt(2)
  v_mfma_f32_16x16x32_bf16 v[92:95], v[124:127], v[24:27], v[92:95]
  v_mfma_f32_16x16x32_bf16 v[100:103], v[124:127], v[40:43], v[100:103]
  s_waitcnt lgkmcnt(1)
  v_mfma_f32_16x16x32_bf16 v[76:79], v[104:107], v[28:31], v[76:79]
  v_mfma_f32_16x16x32_bf16 v[84:87], v[104:107], v[44:47], v[84:87]
  s_waitcnt lgkmcnt(0)
  v_mfma_f32_16x16x32_bf16 v[92:95], v[108:111], v[28:31], v[92:95]
  v_mfma_f32_16x16x32_bf16 v[100:103], v[108:111], v[44:47], v[100:103]
  s_nop 3
  v_sub_f32 v72, v72, v76
  v_sub_f32 v73, v73, v77
  v_sub_f32 v74, v74, v78
  v_sub_f32 v75, v75, v79
  v_sub_f32 v88, v88, v92
  v_sub_f32 v89, v89, v93
  v_sub_f32 v90, v90, v94
  v_sub_f32 v91, v91, v95
  v_sub_f32 v80, v80, v84
  v_sub_f32 v81, v81, v85
  v_sub_f32 v82, v82, v86
  v_sub_f32 v83, v83, v87
  v_sub_f32 v96, v96, v100
  v_sub_f32 v97, v97, v101
  v_sub_f32 v98, v98, v102
  v_sub_f32 v99, v99, v103
  v_mul_f32 v72, v72, v132
  v_mul_f32 v73, v73, v133
  v_mul_f32 v74, v74, v134
  v_mul_f32 v75, v75, v135
  v_cvt_pk_bf16_f32 v104, v72, v73
  v_cvt_pk_bf16_f32 v105, v74, v75
  v_mul_f32 v88, v88, v136
  v_mul_f32 v89, v89, v137
  v_mul_f32 v90, v90, v138
  v_mul_f32 v91, v91, v139
  v_cvt_pk_bf16_f32 v106, v88, v89
  v_cvt_pk_bf16_f32 v107, v90, v91
  v_mul_f32 v80, v80, v132
  v_mul_f32 v81, v81, v133
  v_mul_f32 v82, v82, v134
  v_mul_f32 v83, v83, v135
  v_cvt_pk_bf16_f32 v108, v80, v81
  v_cvt_pk_bf16_f32 v109, v82, v83
  v_mul_f32 v96, v96, v136
  v_mul_f32 v97, v97, v137
  v_mul_f32 v98, v98, v138
  v_mul_f32 v99, v99, v139
  v_cvt_pk_bf16_f32 v110, v96, v97
  v_cvt_pk_bf16_f32 v111, v98, v99
  s_nop 1
  s_branch P1_JOIN
P1_C3:
  ds_read_b128 v[104:107], v128 offset:0
  ds_read_b128 v[108:111], v128 offset:16896
  ds_read_b128 v[112:115], v128 offset:64
  ds_read_b128 v[116:119], v128 offset:16960
  ds_read_b128 v[120:123], v128 offset:128
  s_waitcnt lgkmcnt(4)
  v_mfma_f32_16x16x32_bf16 v[72:75], v[104:107], v[16:19], 0
  ds_read_b128 v[124:127], v128 offset:17024
  v_mfma_f32_16x16x32_bf16 v[80:83], v[104:107], v[32:35], 0
  s_waitcnt lgkmcnt(4)
  v_mfma_f32_16x16x32_bf16 v[88:91], v[108:111], v[16:19], 0
  ds_read_b128 v[104:107], v128 offset:192
  v_mfma_f32_16x16x32_bf16 v[96:99], v[108:111], v[32:35], 0
  s_waitcnt lgkmcnt(4)
  v_mfma_f32_16x16x32_bf16 v[72:75], v[112:115], v[20:23], v[72:75]
  ds_read_b128 v[108:111], v128 offset:17088
  v_mfma_f32_16x16x32_bf16 v[80:83], v[112:115], v[36:39], v[80:83]
  s_waitcnt lgkmcnt(4)
  v_mfma_f32_16x16x32_bf16 v[88:91], v[116:119], v[20:23], v[88:91]
  ds_read_b128 v[112:115], v128 offset:256
  v_mfma_f32_16x16x32_bf16 v[96:99], v[116:119], v[36:39], v[96:99]
  s_waitcnt lgkmcnt(4)
  v_mfma_f32_16x16x32_bf16 v[72:75], v[120:123], v[24:27], v[72:75]
  ds_read_b128 v[116:119], v128 offset:17152
  v_mfma_f32_16x16x32_bf16 v[80:83], v[120:123], v[40:43], v[80:83]
  s_waitcnt lgkmcnt(4)
  v_mfma_f32_16x16x32_bf16 v[88:91], v[124:127], v[24:27], v[88:91]
  ds_read_b128 v[120:123], v128 offset:320
  v_mfma_f32_16x16x32_bf16 v[96:99], v[124:127], v[40:43], v[96:99]
  s_waitcnt lgkmcnt(4)
  v_mfma_f32_16x16x32_bf16 v[72:75], v[104:107], v[28:31], v[72:75]
  ds_read_b128 v[124:127], v128 offset:17216
  v_mfma_f32_16x16x32_bf16 v[80:83], v[104:107], v[44:47], v[80:83]
  s_waitcnt lgkmcnt(4)
  v_mfma_f32_16x16x32_bf16 v[88:91], v[108:111], v[28:31], v[88:91]
  ds_read_b128 v[104:107], v128 offset:384
  v_mfma_f32_16x16x32_bf16 v[96:99], v[108:111], v[44:47], v[96:99]
  s_waitcnt lgkmcnt(4)
  v_mfma_f32_16x16x32_bf16 v[80:83], v[112:115], v[16:19], v[80:83]
  ds_read_b128 v[108:111], v128 offset:17280
  v_mfma_f32_16x16x32_bf16 v[76:79], v[112:115], v[32:35], 0
  s_waitcnt lgkmcnt(4)
  v_mfma_f32_16x16x32_bf16 v[96:99], v[116:119], v[16:19], v[96:99]
  ds_read_b128 v[112:115], v128 offset:448
  v_mfma_f32_16x16x32_bf16 v[92:95], v[116:119], v[32:35], 0
  s_waitcnt lgkmcnt(4)
  v_mfma_f32_16x16x32_bf16 v[80:83], v[120:123], v[20:23], v[80:83]
  ds_read_b128 v[116:119], v128 offset:17344
  v_mfma_f32_16x16x32_bf16 v[76:79], v[120:123], v[36:39], v[76:79]
  s_waitcnt lgkmcnt(4)
  v_mfma_f32_16x16x32_bf16 v[96:99], v[124:127], v[20:23], v[96:99]
  ds_read_b128 v[120:123], v128 offset:512
  v_mfma_f32_16x16x32_bf16 v[92:95], v[124:127], v[36:39], v[92:95]
  s_waitcnt lgkmcnt(4)
  v_mfma_f32_16x16x32_bf16 v[80:83], v[104:107], v[24:27], v[80:83]
  ds_read_b128 v[124:127], v128 offset:17408
  v_mfma_f32_16x16x32_bf16 v[76:79], v[104:107], v[40:43], v[76:79]
  s_waitcnt lgkmcnt(4)
  v_mfma_f32_16x16x32_bf16 v[96:99], v[108:111], v[24:27], v[96:99]
  ds_read_b128 v[104:107], v128 offset:576
  v_mfma_f32_16x16x32_bf16 v[92:95], v[108:111], v[40:43], v[92:95]
  s_waitcnt lgkmcnt(4)
  v_mfma_f32_16x16x32_bf16 v[80:83], v[112:115], v[28:31], v[80:83]
  ds_read_b128 v[108:111], v128 offset:17472
  v_mfma_f32_16x16x32_bf16 v[76:79], v[112:115], v[44:47], v[76:79]
  s_waitcnt lgkmcnt(4)
  v_mfma_f32_16x16x32_bf16 v[96:99], v[116:119], v[28:31], v[96:99]
  ds_read_b128 v[112:115], v128 offset:640
  v_mfma_f32_16x16x32_bf16 v[92:95], v[116:119], v[44:47], v[92:95]
  s_waitcnt lgkmcnt(4)
  v_mfma_f32_16x16x32_bf16 v[76:79], v[120:123], v[16:19], v[76:79]
  ds_read_b128 v[116:119], v128 offset:17536
  v_mfma_f32_16x16x32_bf16 v[84:87], v[120:123], v[32:35], 0
  s_waitcnt lgkmcnt(4)
  v_mfma_f32_16x16x32_bf16 v[92:95], v[124:127], v[16:19], v[92:95]
  ds_read_b128 v[120:123], v128 offset:704
  v_mfma_f32_16x16x32_bf16 v[100:103], v[124:127], v[32:35], 0
  s_waitcnt lgkmcnt(4)
  v_mfma_f32_16x16x32_bf16 v[76:79], v[104:107], v[20:23], v[76:79]
  ds_read_b128 v[124:127], v128 offset:17600
  v_mfma_f32_16x16x32_bf16 v[84:87], v[104:107], v[36:39], v[84:87]
  s_waitcnt lgkmcnt(4)
  v_mfma_f32_16x16x32_bf16 v[92:95], v[108:111], v[20:23], v[92:95]
  ds_read_b128 v[104:107], v128 offset:768
  v_mfma_f32_16x16x32_bf16 v[100:103], v[108:111], v[36:39], v[100:103]
  s_waitcnt lgkmcnt(4)
  v_mfma_f32_16x16x32_bf16 v[76:79], v[112:115], v[24:27], v[76:79]
  ds_read_b128 v[108:111], v128 offset:17664
  v_mfma_f32_16x16x32_bf16 v[84:87], v[112:115], v[40:43], v[84:87]
  s_waitcnt lgkmcnt(4)
  v_mfma_f32_16x16x32_bf16 v[92:95], v[116:119], v[24:27], v[92:95]
  ds_read_b128 v[112:115], v128 offset:832
  v_mfma_f32_16x16x32_bf16 v[100:103], v[116:119], v[40:43], v[100:103]
  s_waitcnt lgkmcnt(4)
  v_mfma_f32_16x16x32_bf16 v[76:79], v[120:123], v[28:31], v[76:79]
  ds_read_b128 v[116:119], v128 offset:17728
  v_mfma_f32_16x16x32_bf16 v[84:87], v[120:123], v[44:47], v[84:87]
  s_waitcnt lgkmcnt(4)
  v_mfma_f32_16x16x32_bf16 v[92:95], v[124:127], v[28:31], v[92:95]
  ds_read_b128 v[120:123], v128 offset:896
  v_mfma_f32_16x16x32_bf16 v[100:103], v[124:127], v[44:47], v[100:103]
  s_waitcnt lgkmcnt(4)
  v_mfma_f32_16x16x32_bf16 v[84:87], v[104:107], v[16:19], v[84:87]
  ds_read_b128 v[124:127], v128 offset:17792
  v_mfma_f32_16x16x32_bf16 v[72:75], v[104:107], v[32:35], v[72:75]
  s_waitcnt lgkmcnt(4)
  v_mfma_f32_16x16x32_bf16 v[100:103], v[108:111], v[16:19], v[100:103]
  ds_read_b128 v[104:107], v128 offset:960
  v_mfma_f32_16x16x32_bf16 v[88:91], v[108:111], v[32:35], v[88:91]
  s_waitcnt lgkmcnt(4)
  v_mfma_f32_16x16x32_bf16 v[84:87], v[112:115], v[20:23], v[84:87]
  ds_read_b128 v[108:111], v128 offset:17856
  v_mfma_f32_16x16x32_bf16 v[72:75], v[112:115], v[36:39], v[72:75]
  s_waitcnt lgkmcnt(4)
  v_mfma_f32_16x16x32_bf16 v[100:103], v[116:119], v[20:23], v[100:103]
  v_mfma_f32_16x16x32_bf16 v[88:91], v[116:119], v[36:39], v[88:91]
  s_waitcnt lgkmcnt(3)
  v_mfma_f32_16x16x32_bf16 v[84:87], v[120:123], v[24:27], v[84:87]
  v_mfma_f32_16x16x32_bf16 v[72:75], v[120:123], v[40:43], v[72:75]
  s_waitcnt lgkmcnt(2)
  v_mfma_f32_16x16x32_bf16 v[100:103], v[124:127], v[24:27], v[100:103]
  v_mfma_f32_16x16x32_bf16 v[88:91], v[124:127], v[40:43], v[88:91]
  s_waitcnt lgkmcnt(1)
  v_mfma_f32_16x16x32_bf16 v[84:87], v[104:107], v[28:31], v[84:87]
  v_mfma_f32_16x16x32_bf16 v[72:75], v[104:107], v[44:47], v[72:75]
  s_waitcnt lgkmcnt(0)
  v_mfma_f32_16x16x32_bf16 v[100:103], v[108:111], v[28:31], v[100:103]
  v_mfma_f32_16x16x32_bf16 v[88:91], v[108:111], v[44:47], v[88:91]
  s_nop 4
  v_sub_f32 v72, v72, v76
  v_sub_f32 v73, v73, v77
  v_sub_f32 v74, v74, v78
  v_sub_f32 v75, v75, v79
  v_sub_f32 v88, v88, v92
  v_sub_f32 v89, v89, v93
  v_sub_f32 v90, v90, v94
  v_sub_f32 v91, v91, v95
  v_sub_f32 v80, v80, v84
  v_sub_f32 v81, v81, v85
  v_sub_f32 v82, v82, v86
  v_sub_f32 v83, v83, v87
  v_sub_f32 v96, v96, v100
  v_sub_f32 v97, v97, v101
  v_sub_f32 v98, v98, v102
  v_sub_f32 v99, v99, v103
  v_mul_f32 v72, v72, v132
  v_mul_f32 v73, v73, v133
  v_mul_f32 v74, v74, v134
  v_mul_f32 v75, v75, v135
  v_cvt_pk_bf16_f32 v104, v72, v73
  v_cvt_pk_bf16_f32 v105, v74, v75
  v_mul_f32 v88, v88, v136
  v_mul_f32 v89, v89, v137
  v_mul_f32 v90, v90, v138
  v_mul_f32 v91, v91, v139
  v_cvt_pk_bf16_f32 v106, v88, v89
  v_cvt_pk_bf16_f32 v107, v90, v91
  v_mul_f32 v80, v80, v132
  v_mul_f32 v81, v81, v133
  v_mul_f32 v82, v82, v134
  v_mul_f32 v83, v83, v135
  v_cvt_pk_bf16_f32 v108, v80, v81
  v_cvt_pk_bf16_f32 v109, v82, v83
  v_mul_f32 v96, v96, v136
  v_mul_f32 v97, v97, v137
  v_mul_f32 v98, v98, v138
  v_mul_f32 v99, v99, v139
  v_cvt_pk_bf16_f32 v110, v96, v97
  v_cvt_pk_bf16_f32 v111, v98, v99
  s_nop 1
P1_JOIN:
  v_mfma_f32_16x16x32_bf16 v[72:75], v[104:107], v[48:51], 0
  v_mfma_f32_16x16x32_bf16 v[80:83], v[104:107], v[56:59], 0
  v_mfma_f32_16x16x32_bf16 v[76:79], v[104:107], v[52:55], 0
  v_mfma_f32_16x16x32_bf16 v[84:87], v[104:107], v[60:63], 0
  v_mfma_f32_16x16x32_bf16 v[72:75], v[108:111], v[64:67], v[72:75]
  v_mfma_f32_16x16x32_bf16 v[80:83], v[108:111], v[48:51], v[80:83]
  v_mfma_f32_16x16x32_bf16 v[76:79], v[108:111], v[68:71], v[76:79]
  v_mfma_f32_16x16x32_bf16 v[84:87], v[108:111], v[52:55], v[84:87]
  s_lshl_b32 s48, s43, 10
  s_lshl_b32 s49, s42, 8
  s_add_u32 s48, s48, s49
  s_lshl_b32 s49, s40, 6
  s_add_u32 s48, s48, s49
  v_lshlrev_b32 v128, 16, v2
  v_lshl_add_u32 v128, v3, 4, v128
  v_add_u32 v128, s48, v128
  v_add_u32 v129, 0x100000, v128
  v_cvt_pk_bf16_f32 v112, v72, v80
  v_cvt_pk_bf16_f32 v113, v73, v81
  v_cvt_pk_bf16_f32 v114, v74, v82
  v_cvt_pk_bf16_f32 v115, v75, v83
  global_store_dwordx4 v128, v[112:115], s[24:25] sc1
  v_cvt_pk_bf16_f32 v116, v76, v84
  v_cvt_pk_bf16_f32 v117, v77, v85
  v_cvt_pk_bf16_f32 v118, v78, v86
  v_cvt_pk_bf16_f32 v119, v79, v87
  global_store_dwordx4 v129, v[116:119], s[24:25] sc1
  v_mov_b32 v255, 0
  global_load_dword v254, v255, s[20:21] sc1
  s_lshl_b32 s48, s40, 4
  v_add_u32 v10, s48, v2
  v_cvt_f32_u32 v10, v10
  v_mul_f32 v10, 0x3c800000, v10
  v_lshlrev_b32 v11, 3, v3
  v_cvt_f32_u32 v11, v11
  v_mul_f32 v11, v10, v11
  v_mov_b32 v4, v11
  v_fmamk_f32 v5, v10, 0x3f800000, v11
  v_cos_f32 v6, v4
  v_cos_f32 v7, v5
  v_sin_f32_e64 v8, v4
  v_sin_f32_e64 v9, v5
  v_cvt_pk_bf16_f32 v12, v6, v7
  v_cvt_pk_bf16_f32 v20, v8, v9
  v_xor_b32 v28, s67, v20
  v_fmamk_f32 v4, v10, 0x40000000, v11
  v_fmamk_f32 v5, v10, 0x40400000, v11
  v_cos_f32 v6, v4
  v_cos_f32 v7, v5
  v_sin_f32_e64 v8, v4
  v_sin_f32_e64 v9, v5
  v_cvt_pk_bf16_f32 v13, v6, v7
  v_cvt_pk_bf16_f32 v21, v8, v9
  v_xor_b32 v29, s67, v21
  v_fmamk_f32 v4, v10, 0x40800000, v11
  v_fmamk_f32 v5, v10, 0x40a00000, v11
  v_cos_f32 v6, v4
  v_cos_f32 v7, v5
  v_sin_f32_e64 v8, v4
  v_sin_f32_e64 v9, v5
  v_cvt_pk_bf16_f32 v14, v6, v7
  v_cvt_pk_bf16_f32 v22, v8, v9
  v_xor_b32 v30, s67, v22
  v_fmamk_f32 v4, v10, 0x40c00000, v11
  v_fmamk_f32 v5, v10, 0x40e00000, v11
  v_cos_f32 v6, v4
  v_cos_f32 v7, v5
  v_sin_f32_e64 v8, v4
  v_sin_f32_e64 v9, v5
  v_cvt_pk_bf16_f32 v15, v6, v7
  v_cvt_pk_bf16_f32 v23, v8, v9
  v_xor_b32 v31, s67, v23
  v_fmamk_f32 v4, v10, 0x42000000, v11
  v_fmamk_f32 v5, v10, 0x42040000, v11
  v_cos_f32 v6, v4
  v_cos_f32 v7, v5
  v_sin_f32_e64 v8, v4
  v_sin_f32_e64 v9, v5
  v_cvt_pk_bf16_f32 v16, v6, v7
  v_cvt_pk_bf16_f32 v24, v8, v9
  v_xor_b32 v32, s67, v24
  v_fmamk_f32 v4, v10, 0x42080000, v11
  v_fmamk_f32 v5, v10, 0x420c0000, v11
  v_cos_f32 v6, v4
  v_cos_f32 v7, v5
  v_sin_f32_e64 v8, v4
  v_sin_f32_e64 v9, v5
  v_cvt_pk_bf16_f32 v17, v6, v7
  v_cvt_pk_bf16_f32 v25, v8, v9
  v_xor_b32 v33, s67, v25
  v_fmamk_f32 v4, v10, 0x42100000, v11
  v_fmamk_f32 v5, v10, 0x42140000, v11
  v_cos_f32 v6, v4
  v_cos_f32 v7, v5
  v_sin_f32_e64 v8, v4
  v_sin_f32_e64 v9, v5
  v_cvt_pk_bf16_f32 v18, v6, v7
  v_cvt_pk_bf16_f32 v26, v8, v9
  v_xor_b32 v34, s67, v26
  v_fmamk_f32 v4, v10, 0x42180000, v11
  v_fmamk_f32 v5, v10, 0x421c0000, v11
  v_cos_f32 v6, v4
  v_cos_f32 v7, v5
  v_sin_f32_e64 v8, v4
  v_sin_f32_e64 v9, v5
  v_cvt_pk_bf16_f32 v19, v6, v7
  v_cvt_pk_bf16_f32 v27, v8, v9
  v_xor_b32 v35, s67, v27
  s_lshl_b32 s48, s45, 16
  s_lshl_b32 s49, s46, 7
  s_add_u32 s48, s48, s49
  v_lshlrev_b32 v116, 13, v3
  v_lshl_add_u32 v116, v2, 3, v116
  v_add_u32 v116, s48, v116
  v_add_u32 v117, 4096, v116
  v_add_u32 v118, 32768, v116
  v_add_u32 v119, 36864, v116
  v_lshlrev_b32 v120, 1, v2
  v_mul_u32_u24 v120, 288, v120
  v_lshl_add_u32 v120, v3, 3, v120
  s_lshl_b32 s48, s40, 5
  s_add_u32 s48, s48, 114688
  v_add_u32 v120, s48, v120
  v_mul_u32_u24 v121, 288, v2
  v_lshl_add_u32 v121, v3, 4, v121
  v_add_u32 v121, 114688, v121
  s_lshl_b32 s48, s40, 19
  s_lshl_b32 s49, s45, 10
  s_add_u32 s48, s48, s49
  s_lshl_b32 s49, s46, 7
  s_add_u32 s48, s48, s49
  v_lshlrev_b32 v122, 15, v2
  v_lshl_add_u32 v122, v3, 4, v122
  v_add_u32 v122, s48, v122
  v_bfe_u32 v252, v1, 2, 2
  v_subrev_u32 v128, 48, v1
  v_bfe_u32 v128, v128, 1, 2
  v_cmp_gt_u32 vcc, 48, v1
  s_nop 1
  v_cndmask_b32 v252, v128, v252, vcc
  v_mul_u32_u24 v252, 3584, v252
  v_lshrrev_b32 v128, 4, v1
  v_lshlrev_b32 v128, 2, v128
  v_and_b32 v129, 3, v1
  v_add_u32 v128, v128, v129
  v_and_b32 v129, 1, v1
  v_add_u32 v129, 12, v129
  v_cndmask_b32 v128, v129, v128, vcc
  v_lshl_add_u32 v252, v128, 4, v252
  s_waitcnt vmcnt(0)
  s_mov_b32 s71, 0
L_RDYPOLL:
  s_add_u32 s71, s71, 1
  s_cmp_gt_u32 s71, 0x100000
  s_cbranch_scc1 L_END
  v_cmp_eq_u32 vcc, 0, v254
  s_nop 3
  s_cmp_eq_u64 vcc, 0
  s_cbranch_scc1 L_RDYOK
  v_mov_b32 v255, 0
  global_load_dword v254, v255, s[20:21] sc1
  s_waitcnt vmcnt(0)
  s_branch L_RDYPOLL
L_RDYOK:
  s_waitcnt lgkmcnt(0)
  s_barrier
  s_cmp_eq_u32 s40, 0
  s_cbranch_scc0 B1_NOARR
  s_and_b32 s48, s43, 7
  s_lshl_b32 s49, s42, 3
  s_add_u32 s48, s48, s49
  s_lshl_b32 s48, s48, 8
  v_mov_b32 v255, s48
  v_mov_b32 v254, 1
  s_mov_b64 exec, 1
  global_atomic_add v255, v254, s[34:35] sc1
  s_mov_b64 exec, -1
B1_NOARR:
  v_mov_b32 v236, 0
  v_mov_b32 v237, 0
  v_mov_b32 v238, 0
  v_mov_b32 v239, 0
  v_mov_b32 v240, 0
  v_mov_b32 v241, 0
  v_mov_b32 v242, 0
  v_mov_b32 v243, 0
  v_mov_b32 v244, 0
  v_mov_b32 v245, 0
  v_mov_b32 v246, 0
  v_mov_b32 v247, 0
  v_mov_b32 v248, 0
  v_mov_b32 v249, 0
  v_mov_b32 v250, 0
  v_mov_b32 v251, 0
  s_lshr_b32 s48, s46, 1
  s_lshl_b32 s48, s48, 6
  s_and_b32 s49, s46, 1
  s_lshl_b32 s49, s49, 1
  s_add_u32 s48, s48, s49
  v_and_b32 v128, 7, v2
  v_lshlrev_b32 v128, 3, v128
  v_lshrrev_b32 v129, 3, v2
  v_add3_u32 v128, v128, v129, s48
  v_add_u32 v129, 4, v128
  v_cmp_eq_u32 vcc, 0, v128
  v_mov_b32 v130, 0x100
  s_nop 0
  v_cndmask_b32 v128, v128, v130, vcc
  s_lshl_b32 s48, s40, 9
  s_add_u32 s48, s48, s45
  v_lshl_add_u32 v130, v3, 7, s48
  v_mul_u32_u24 v130, 514, v130
  v_lshl_add_u32 v131, v128, 1, v130
  v_add_u32 v132, 16448, v131
  v_add_u32 v133, 32896, v131
  v_add_u32 v134, 49344, v131
  v_lshl_add_u32 v135, v129, 1, v130
  v_add_u32 v136, 16448, v135
  v_add_u32 v137, 32896, v135
  v_add_u32 v138, 49344, v135
  global_load_short_d16_hi v236, v131, s[6:7]
  global_load_short_d16_hi v244, v131, s[8:9]
  global_load_short_d16_hi v237, v132, s[6:7]
  global_load_short_d16_hi v245, v132, s[8:9]
  global_load_short_d16_hi v238, v133, s[6:7]
  global_load_short_d16_hi v246, v133, s[8:9]
  global_load_short_d16_hi v239, v134, s[6:7]
  global_load_short_d16_hi v247, v134, s[8:9]
  global_load_short_d16_hi v240, v135, s[6:7]
  global_load_short_d16_hi v248, v135, s[8:9]
  global_load_short_d16_hi v241, v136, s[6:7]
  global_load_short_d16_hi v249, v136, s[8:9]
  global_load_short_d16_hi v242, v137, s[6:7]
  global_load_short_d16_hi v250, v137, s[8:9]
  global_load_short_d16_hi v243, v138, s[6:7]
  global_load_short_d16_hi v251, v138, s[8:9]
  v_lshrrev_b32 v176, 5, v1
  v_lshlrev_b32 v176, 8, v176
  v_bfe_u32 v177, v1, 2, 2
  v_lshl_add_u32 v176, v177, 6, v176
  v_bfe_u32 v177, v1, 4, 1
  v_lshl_add_u32 v176, v177, 5, v176
  v_and_b32 v177, 3, v1
  v_lshl_add_u32 v176, v177, 3, v176
  v_add_u32 v176, s70, v176
  ds_read_b64_tr_b16 v[160:161], v176 offset:0
  ds_read_b64_tr_b16 v[162:163], v176 offset:512
  ds_read_b64_tr_b16 v[164:165], v176 offset:1024
  ds_read_b64_tr_b16 v[166:167], v176 offset:1536
  v_lshl_add_u32 v177, v1, 4, s10
  v_lshl_add_u32 v178, v1, 4, s11
  s_waitcnt lgkmcnt(2)
  global_store_dwordx4 v177, v[160:163], s[22:23] sc1
  s_waitcnt lgkmcnt(0)
  global_store_dwordx4 v178, v[164:167], s[22:23] sc1
  s_waitcnt lgkmcnt(0)
  s_add_u32 m0, s70, 0
  s_mov_b64 exec, s[38:39]
  global_load_lds_dwordx4 v252, s[36:37]
  s_mov_b64 exec, -1
  v_add_u32 v252, 14336, v252
  s_add_u32 m0, s70, 896
  s_mov_b64 exec, s[38:39]
  global_load_lds_dwordx4 v252, s[36:37]
  s_mov_b64 exec, -1
  v_add_u32 v252, 14336, v252
  s_add_u32 m0, s70, 1792
  s_mov_b64 exec, s[38:39]
  global_load_lds_dwordx4 v252, s[36:37]
  s_mov_b64 exec, -1
  v_add_u32 v252, 14336, v252
  s_add_u32 m0, s70, 2688
  s_mov_b64 exec, s[38:39]
  global_load_lds_dwordx4 v252, s[36:37]
  s_mov_b64 exec, -1
  v_add_u32 v252, 14336, v252
  s_add_u32 m0, s70, 3584
  s_mov_b64 exec, s[38:39]
  global_load_lds_dwordx4 v252, s[36:37]
  s_mov_b64 exec, -1
  v_add_u32 v252, 14336, v252
  s_add_u32 m0, s70, 4480
  s_mov_b64 exec, s[38:39]
  global_load_lds_dwordx4 v252, s[36:37]
  s_mov_b64 exec, -1
  v_add_u32 v252, 14336, v252
  s_add_u32 m0, s70, 5376
  s_mov_b64 exec, s[38:39]
  global_load_lds_dwordx4 v252, s[36:37]
  s_mov_b64 exec, -1
  v_add_u32 v252, 14336, v252
  s_add_u32 m0, s70, 6272
  s_mov_b64 exec, s[38:39]
  global_load_lds_dwordx4 v252, s[36:37]
  s_mov_b64 exec, -1
  v_add_u32 v252, 14336, v252
  s_add_u32 m0, s70, 7168
  s_mov_b64 exec, s[38:39]
  global_load_lds_dwordx4 v252, s[36:37]
  s_mov_b64 exec, -1
  v_add_u32 v252, 14336, v252
  s_add_u32 m0, s70, 8064
  s_mov_b64 exec, s[38:39]
  global_load_lds_dwordx4 v252, s[36:37]
  s_mov_b64 exec, -1
  v_add_u32 v252, 14336, v252
  s_add_u32 m0, s70, 8960
  s_mov_b64 exec, s[38:39]
  global_load_lds_dwordx4 v252, s[36:37]
  s_mov_b64 exec, -1
  v_add_u32 v252, 14336, v252
  s_add_u32 m0, s70, 9856
  s_mov_b64 exec, s[38:39]
  global_load_lds_dwordx4 v252, s[36:37]
  s_mov_b64 exec, -1
  v_add_u32 v252, 14336, v252
  s_getpc_b64 s[50:51]
L_PF0:
  v_lshlrev_b32 v128, 7, v0
  v_add_u32 v128, L_P2CODE-L_PF0, v128
  v_min_u32 v128, L_P3CODE-L_PF0, v128
  global_load_dword v129, v128, s[50:51]
  s_and_b32 s3, s40, 1
  s_xor_b32 s48, s3, 1
  s_mul_i32 s3, s3, 28672
  s_mul_i32 s48, s48, 28672
  v_lshl_add_u32 v253, v1, 4, s48
  s_cmp_eq_u32 s40, 0
  s_cbranch_scc0 B1_NOPOLL
  s_mov_b32 s48, 0
  v_min_u32 v255, 31, v1
  v_lshlrev_b32 v255, 8, v255
  v_add_u32 v255, s48, v255
  s_mov_b32 s71, 0
  s_nop 0
B1_POLL:
  s_add_u32 s71, s71, 1
  s_cmp_gt_u32 s71, 0x100000
  s_cbranch_scc1 L_END
  global_load_dword v254, v255, s[34:35] sc1
  s_waitcnt vmcnt(0)
  v_cmp_le_u32 vcc, 8, v254
  s_nop 3
  s_cmp_eq_u64 vcc, exec
  s_cbranch_scc0 B1_POLL
B1_NOPOLL:
  s_barrier
L_P2CODE:
  global_load_dwordx2 v[36:37], v116, s[24:25] offset:0 sc1
  global_load_dwordx2 v[38:39], v116, s[24:25] offset:1024 sc1
  global_load_dwordx2 v[40:41], v116, s[24:25] offset:2048 sc1
  global_load_dwordx2 v[42:43], v116, s[24:25] offset:3072 sc1
  global_load_dwordx2 v[44:45], v117, s[24:25] offset:0 sc1
  global_load_dwordx2 v[46:47], v117, s[24:25] offset:1024 sc1
  global_load_dwordx2 v[48:49], v117, s[24:25] offset:2048 sc1
  global_load_dwordx2 v[50:51], v117, s[24:25] offset:3072 sc1
  global_load_dwordx2 v[52:53], v118, s[24:25] offset:0 sc1
  global_load_dwordx2 v[54:55], v118, s[24:25] offset:1024 sc1
  global_load_dwordx2 v[56:57], v118, s[24:25] offset:2048 sc1
  global_load_dwordx2 v[58:59], v118, s[24:25] offset:3072 sc1
  global_load_dwordx2 v[60:61], v119, s[24:25] offset:0 sc1
  global_load_dwordx2 v[62:63], v119, s[24:25] offset:1024 sc1
  global_load_dwordx2 v[64:65], v119, s[24:25] offset:2048 sc1
  global_load_dwordx2 v[66:67], v119, s[24:25] offset:3072 sc1
  s_and_b32 s48, s40, 1
  s_lshl_b32 s48, s48, 4
  s_lshl_b32 s49, s42, 5
  s_add_u32 s48, s48, s49
  v_add_u32 v136, s48, v2
  v_cvt_f32_u32 v134, v136
  v_mul_f32 v134, 0x3b000000, v134
  v_lshrrev_b32 v135, 1, v3
  v_lshlrev_b32 v135, 6, v135
  v_and_b32 v128, 1, v3
  v_lshl_add_u32 v135, v128, 3, v135
  v_cvt_f32_u32 v135, v135
  v_mul_f32 v135, v134, v135
  v_mov_b32 v128, v135
  s_waitcnt vmcnt(16)
  v_fmamk_f32 v129, v134, 0x41800000, v135
  v_cos_f32 v130, v128
  v_cos_f32 v131, v129
  v_sin_f32_e64 v132, -v128
  v_sin_f32_e64 v133, -v129
  v_cvt_pk_bf16_f32 v160, v130, v131
  v_cvt_pk_bf16_f32 v192, v132, v133
  v_fmamk_f32 v128, v134, 0x42000000, v135
  v_fmamk_f32 v129, v134, 0x42400000, v135
  v_cos_f32 v130, v128
  v_cos_f32 v131, v129
  v_sin_f32_e64 v132, -v128
  v_sin_f32_e64 v133, -v129
  v_cvt_pk_bf16_f32 v161, v130, v131
  v_cvt_pk_bf16_f32 v193, v132, v133
  v_fmamk_f32 v128, v134, 0x40800000, v135
  v_fmamk_f32 v129, v134, 0x41a00000, v135
  v_cos_f32 v130, v128
  v_cos_f32 v131, v129
  v_sin_f32_e64 v132, -v128
  v_sin_f32_e64 v133, -v129
  v_cvt_pk_bf16_f32 v162, v130, v131
  v_cvt_pk_bf16_f32 v194, v132, v133
  v_fmamk_f32 v128, v134, 0x42100000, v135
  v_fmamk_f32 v129, v134, 0x42500000, v135
  v_cos_f32 v130, v128
  v_cos_f32 v131, v129
  v_sin_f32_e64 v132, -v128
  v_sin_f32_e64 v133, -v129
  v_cvt_pk_bf16_f32 v163, v130, v131
  v_cvt_pk_bf16_f32 v195, v132, v133
  v_fmamk_f32 v128, v134, 0x40000000, v135
  v_fmamk_f32 v129, v134, 0x41900000, v135
  v_cos_f32 v130, v128
  v_cos_f32 v131, v129
  v_sin_f32_e64 v132, -v128
  v_sin_f32_e64 v133, -v129
  v_cvt_pk_bf16_f32 v176, v130, v131
  v_cvt_pk_bf16_f32 v208, v132, v133
  v_fmamk_f32 v128, v134, 0x42080000, v135
  v_fmamk_f32 v129, v134, 0x42480000, v135
  v_cos_f32 v130, v128
  v_cos_f32 v131, v129
  v_sin_f32_e64 v132, -v128
  v_sin_f32_e64 v133, -v129
  v_cvt_pk_bf16_f32 v177, v130, v131
  v_cvt_pk_bf16_f32 v209, v132, v133
  v_fmamk_f32 v128, v134, 0x40c00000, v135
  v_fmamk_f32 v129, v134, 0x41b00000, v135
  v_cos_f32 v130, v128
  v_cos_f32 v131, v129
  v_sin_f32_e64 v132, -v128
  v_sin_f32_e64 v133, -v129
  v_cvt_pk_bf16_f32 v178, v130, v131
  v_cvt_pk_bf16_f32 v210, v132, v133
  v_fmamk_f32 v128, v134, 0x42180000, v135
  v_fmamk_f32 v129, v134, 0x42580000, v135
  v_cos_f32 v130, v128
  v_cos_f32 v131, v129
  v_sin_f32_e64 v132, -v128
  v_sin_f32_e64 v133, -v129
  v_cvt_pk_bf16_f32 v179, v130, v131
  v_cvt_pk_bf16_f32 v211, v132, v133
  v_bfe_u32 v128, v136, 1, 1
  v_mul_u32_u24 v137, 0x8000, v128
  v_lshl_or_b32 v137, v137, 16, v137
  v_add_u32 v128, 1, v136
  v_bfe_u32 v128, v128, 1, 1
  v_mul_u32_u24 v138, 0x8000, v128
  v_lshl_or_b32 v138, v138, 16, v138
  v_and_b32 v128, 1, v136
  v_cmp_eq_u32 vcc, 1, v128
  s_nop 1
  v_cndmask_b32 v164, v160, v192, vcc
  v_cndmask_b32 v196, v192, v160, vcc
  v_xor_b32 v164, v137, v164
  v_xor_b32 v196, v138, v196
  v_cndmask_b32 v165, v161, v193, vcc
  v_cndmask_b32 v197, v193, v161, vcc
  v_xor_b32 v165, v137, v165
  v_xor_b32 v197, v138, v197
  v_cndmask_b32 v166, v162, v194, vcc
  v_cndmask_b32 v198, v194, v162, vcc
  v_xor_b32 v166, v137, v166
  v_xor_b32 v198, v138, v198
  v_cndmask_b32 v167, v163, v195, vcc
  v_cndmask_b32 v199, v195, v163, vcc
  v_xor_b32 v167, v137, v167
  v_xor_b32 v199, v138, v199
  v_cndmask_b32 v180, v176, v208, vcc
  v_cndmask_b32 v212, v208, v176, vcc
  v_xor_b32 v180, v137, v180
  v_xor_b32 v212, v138, v212
  v_cndmask_b32 v181, v177, v209, vcc
  v_cndmask_b32 v213, v209, v177, vcc
  v_xor_b32 v181, v137, v181
  v_xor_b32 v213, v138, v213
  v_cndmask_b32 v182, v178, v210, vcc
  v_cndmask_b32 v214, v210, v178, vcc
  v_xor_b32 v182, v137, v182
  v_xor_b32 v214, v138, v214
  v_cndmask_b32 v183, v179, v211, vcc
  v_cndmask_b32 v215, v211, v179, vcc
  v_xor_b32 v183, v137, v183
  v_xor_b32 v215, v138, v215
  v_mul_f32 v128, 0x43800000, v134
  v_cos_f32 v128, v128
  s_nop 0
  v_mul_f32 v128, 0.5, v128
  v_cvt_pk_bf16_f32 v128, v128, v128
  v_and_b32 v128, 0xffff, v128
  v_and_b32 v129, 0xffff0000, v160
  v_or_b32 v128, v128, v129
  v_and_b32 v129, 0xffff0000, v192
  v_cmp_eq_u32 vcc, 0, v3
  s_nop 1
  v_cndmask_b32 v160, v160, v128, vcc
  v_cndmask_b32 v192, v192, v129, vcc
  s_waitcnt vmcnt(14)
  v_perm_b32 v68, v38, v36, s65
  v_perm_b32 v84, v38, v36, s66
  v_perm_b32 v76, v39, v37, s65
  v_perm_b32 v92, v39, v37, s66
  s_waitcnt vmcnt(12)
  v_perm_b32 v69, v42, v40, s65
  v_perm_b32 v85, v42, v40, s66
  v_perm_b32 v77, v43, v41, s65
  v_perm_b32 v93, v43, v41, s66
  s_waitcnt vmcnt(10)
  v_perm_b32 v70, v46, v44, s65
  v_perm_b32 v86, v46, v44, s66
  v_perm_b32 v78, v47, v45, s65
  v_perm_b32 v94, v47, v45, s66
  s_waitcnt vmcnt(8)
  v_perm_b32 v71, v50, v48, s65
  v_perm_b32 v87, v50, v48, s66
  v_perm_b32 v79, v51, v49, s65
  v_perm_b32 v95, v51, v49, s66
  v_mfma_f32_16x16x32_bf16 v[100:103], v[12:15], v[68:71], 0
  v_mfma_f32_16x16x32_bf16 v[108:111], v[12:15], v[84:87], 0
  v_mfma_f32_16x16x32_bf16 v[100:103], v[20:23], v[84:87], v[100:103]
  v_mfma_f32_16x16x32_bf16 v[108:111], v[28:31], v[68:71], v[108:111]
  v_mfma_f32_16x16x32_bf16 v[104:107], v[12:15], v[76:79], 0
  v_mfma_f32_16x16x32_bf16 v[112:115], v[12:15], v[92:95], 0
  v_mfma_f32_16x16x32_bf16 v[104:107], v[20:23], v[92:95], v[104:107]
  v_mfma_f32_16x16x32_bf16 v[112:115], v[28:31], v[76:79], v[112:115]
  s_waitcnt vmcnt(6)
  v_perm_b32 v72, v54, v52, s65
  v_perm_b32 v88, v54, v52, s66
  v_perm_b32 v80, v55, v53, s65
  v_perm_b32 v96, v55, v53, s66
  s_waitcnt vmcnt(4)
  v_perm_b32 v73, v58, v56, s65
  v_perm_b32 v89, v58, v56, s66
  v_perm_b32 v81, v59, v57, s65
  v_perm_b32 v97, v59, v57, s66
  s_waitcnt vmcnt(2)
  v_perm_b32 v74, v62, v60, s65
  v_perm_b32 v90, v62, v60, s66
  v_perm_b32 v82, v63, v61, s65
  v_perm_b32 v98, v63, v61, s66
  s_waitcnt vmcnt(0)
  v_perm_b32 v75, v66, v64, s65
  v_perm_b32 v91, v66, v64, s66
  v_perm_b32 v83, v67, v65, s65
  v_perm_b32 v99, v67, v65, s66
  v_mfma_f32_16x16x32_bf16 v[100:103], v[16:19], v[72:75], v[100:103]
  v_mfma_f32_16x16x32_bf16 v[108:111], v[16:19], v[88:91], v[108:111]
  v_mfma_f32_16x16x32_bf16 v[100:103], v[24:27], v[88:91], v[100:103]
  v_mfma_f32_16x16x32_bf16 v[108:111], v[32:35], v[72:75], v[108:111]
  v_mfma_f32_16x16x32_bf16 v[104:107], v[16:19], v[80:83], v[104:107]
  v_mfma_f32_16x16x32_bf16 v[112:115], v[16:19], v[96:99], v[112:115]
  v_mfma_f32_16x16x32_bf16 v[104:107], v[24:27], v[96:99], v[104:107]
  v_mfma_f32_16x16x32_bf16 v[112:115], v[32:35], v[80:83], v[112:115]
  s_nop 2
  v_mul_f32 v36, v100, v236
  v_mul_f32 v40, v100, v244
  v_mul_f32 v37, v101, v237
  v_mul_f32 v41, v101, v245
  v_mul_f32 v38, v102, v238
  v_mul_f32 v42, v102, v246
  v_mul_f32 v39, v103, v239
  v_mul_f32 v43, v103, v247
  v_fma_f32 v36, -v108, v244, v36
  v_fma_f32 v40, v108, v236, v40
  v_fma_f32 v37, -v109, v245, v37
  v_fma_f32 v41, v109, v237, v41
  v_fma_f32 v38, -v110, v246, v38
  v_fma_f32 v42, v110, v238, v42
  v_fma_f32 v39, -v111, v247, v39
  v_fma_f32 v43, v111, v239, v43
  v_cvt_pk_bf16_f32 v44, v36, v37
  v_cvt_pk_bf16_f32 v45, v38, v39
  v_cvt_pk_bf16_f32 v46, v40, v41
  v_cvt_pk_bf16_f32 v47, v42, v43
  ds_write_b64 v120, v[44:45] offset:0
  ds_write_b64 v120, v[46:47] offset:128
  v_mul_f32 v52, v104, v240
  v_mul_f32 v56, v104, v248
  v_mul_f32 v53, v105, v241
  v_mul_f32 v57, v105, v249
  v_mul_f32 v54, v106, v242
  v_mul_f32 v58, v106, v250
  v_mul_f32 v55, v107, v243
  v_mul_f32 v59, v107, v251
  v_fma_f32 v52, -v112, v248, v52
  v_fma_f32 v56, v112, v240, v56
  v_fma_f32 v53, -v113, v249, v53
  v_fma_f32 v57, v113, v241, v57
  v_fma_f32 v54, -v114, v250, v54
  v_fma_f32 v58, v114, v242, v58
  v_fma_f32 v55, -v115, v251, v55
  v_fma_f32 v59, v115, v243, v59
  v_cvt_pk_bf16_f32 v60, v52, v53
  v_cvt_pk_bf16_f32 v61, v54, v55
  v_cvt_pk_bf16_f32 v62, v56, v57
  v_cvt_pk_bf16_f32 v63, v58, v59
  ds_write_b64 v120, v[60:61] offset:288
  ds_write_b64 v120, v[62:63] offset:416
  s_waitcnt lgkmcnt(0)
  s_barrier
  ds_read_b128 v[68:71], v121 offset:0
  ds_read_b128 v[84:87], v121 offset:128
  ds_read_b128 v[72:75], v121 offset:64
  ds_read_b128 v[88:91], v121 offset:192
  ds_read_b128 v[76:79], v121 offset:4608
  ds_read_b128 v[92:95], v121 offset:4736
  ds_read_b128 v[80:83], v121 offset:4672
  ds_read_b128 v[96:99], v121 offset:4800
  s_waitcnt lgkmcnt(7)
  v_mfma_f32_16x16x32_bf16 v[100:103], v[68:71], v[12:15], 0
  v_mfma_f32_16x16x32_bf16 v[108:111], v[68:71], v[20:23], 0
  s_waitcnt lgkmcnt(6)
  v_mfma_f32_16x16x32_bf16 v[100:103], v[84:87], v[28:31], v[100:103]
  v_mfma_f32_16x16x32_bf16 v[108:111], v[84:87], v[12:15], v[108:111]
  s_waitcnt lgkmcnt(5)
  v_mfma_f32_16x16x32_bf16 v[100:103], v[72:75], v[16:19], v[100:103]
  v_mfma_f32_16x16x32_bf16 v[108:111], v[72:75], v[24:27], v[108:111]
  s_waitcnt lgkmcnt(4)
  v_mfma_f32_16x16x32_bf16 v[100:103], v[88:91], v[32:35], v[100:103]
  v_mfma_f32_16x16x32_bf16 v[108:111], v[88:91], v[16:19], v[108:111]
  s_waitcnt lgkmcnt(3)
  v_mfma_f32_16x16x32_bf16 v[104:107], v[76:79], v[12:15], 0
  v_mfma_f32_16x16x32_bf16 v[112:115], v[76:79], v[20:23], 0
  s_waitcnt lgkmcnt(2)
  v_mfma_f32_16x16x32_bf16 v[104:107], v[92:95], v[28:31], v[104:107]
  v_mfma_f32_16x16x32_bf16 v[112:115], v[92:95], v[12:15], v[112:115]
  s_waitcnt lgkmcnt(1)
  v_mfma_f32_16x16x32_bf16 v[104:107], v[80:83], v[16:19], v[104:107]
  v_mfma_f32_16x16x32_bf16 v[112:115], v[80:83], v[24:27], v[112:115]
  s_waitcnt lgkmcnt(0)
  v_mfma_f32_16x16x32_bf16 v[104:107], v[96:99], v[32:35], v[104:107]
  v_mfma_f32_16x16x32_bf16 v[112:115], v[96:99], v[16:19], v[112:115]
  v_cvt_pk_bf16_f32 v36, v100, v108
  v_cvt_pk_bf16_f32 v37, v101, v109
  v_cvt_pk_bf16_f32 v38, v102, v110
  v_cvt_pk_bf16_f32 v39, v103, v111
  global_store_dwordx4 v122, v[36:39], s[26:27] offset:0 sc1
  s_nop 2
  v_cvt_pk_bf16_f32 v40, v104, v112
  v_cvt_pk_bf16_f32 v41, v105, v113
  v_cvt_pk_bf16_f32 v42, v106, v114
  v_cvt_pk_bf16_f32 v43, v107, v115
  global_store_dwordx4 v122, v[40:43], s[26:27] offset:64 sc1
  s_lshr_b32 s50, s40, 1
  s_and_b32 s51, s40, 1
  s_lshl_b32 s48, s50, 4
  v_add_u32 v144, s48, v2
  v_lshl_add_u32 v144, v144, 6, s43
  v_lshlrev_b32 v144, 10, v144
  v_lshl_add_u32 v144, v3, 3, v144
  s_lshl_b32 s48, s42, 6
  s_lshl_b32 s49, s51, 5
  s_add_u32 s48, s48, s49
  v_add_u32 v144, s48, v144
  global_load_dwordx2 v[136:137], v144, s[4:5] offset:0
  global_load_dwordx2 v[138:139], v144, s[4:5] offset:256
  global_load_dwordx2 v[140:141], v144, s[4:5] offset:512
  global_load_dwordx2 v[142:143], v144, s[4:5] offset:768
  v_add_u32 v10, 0, v2
  v_lshl_add_u32 v10, v10, 6, s43
  v_cvt_f32_u32 v10, v10
  v_mul_f32 v10, 0x3a000000, v10
  v_lshlrev_b32 v11, 3, v3
  v_cvt_f32_u32 v11, v11
  v_mul_f32 v11, v10, v11
  v_mov_b32 v4, v11
  v_fmamk_f32 v5, v10, 0x3f800000, v11
  v_cos_f32 v6, v4
  v_cos_f32 v7, v5
  v_sin_f32_e64 v8, v4
  v_sin_f32_e64 v9, v5
  v_cvt_pk_bf16_f32 v16, v6, v7
  v_cvt_pk_bf16_f32 v24, v8, v9
  v_xor_b32 v32, s67, v24
  v_fmamk_f32 v4, v10, 0x40000000, v11
  v_fmamk_f32 v5, v10, 0x40400000, v11
  v_cos_f32 v6, v4
  v_cos_f32 v7, v5
  v_sin_f32_e64 v8, v4
  v_sin_f32_e64 v9, v5
  v_cvt_pk_bf16_f32 v17, v6, v7
  v_cvt_pk_bf16_f32 v25, v8, v9
  v_xor_b32 v33, s67, v25
  v_fmamk_f32 v4, v10, 0x40800000, v11
  v_fmamk_f32 v5, v10, 0x40a00000, v11
  v_cos_f32 v6, v4
  v_cos_f32 v7, v5
  v_sin_f32_e64 v8, v4
  v_sin_f32_e64 v9, v5
  v_cvt_pk_bf16_f32 v18, v6, v7
  v_cvt_pk_bf16_f32 v26, v8, v9
  v_xor_b32 v34, s67, v26
  v_fmamk_f32 v4, v10, 0x40c00000, v11
  v_fmamk_f32 v5, v10, 0x40e00000, v11
  v_cos_f32 v6, v4
  v_cos_f32 v7, v5
  v_sin_f32_e64 v8, v4
  v_sin_f32_e64 v9, v5
  v_cvt_pk_bf16_f32 v19, v6, v7
  v_cvt_pk_bf16_f32 v27, v8, v9
  v_xor_b32 v35, s67, v27
  v_add_u32 v10, 16, v2
  v_lshl_add_u32 v10, v10, 6, s43
  v_cvt_f32_u32 v10, v10
  v_mul_f32 v10, 0x3a000000, v10
  v_lshlrev_b32 v11, 3, v3
  v_cvt_f32_u32 v11, v11
  v_mul_f32 v11, v10, v11
  v_mov_b32 v4, v11
  v_fmamk_f32 v5, v10, 0x3f800000, v11
  v_cos_f32 v6, v4
  v_cos_f32 v7, v5
  v_sin_f32_e64 v8, v4
  v_sin_f32_e64 v9, v5
  v_cvt_pk_bf16_f32 v20, v6, v7
  v_cvt_pk_bf16_f32 v28, v8, v9
  v_xor_b32 v36, s67, v28
  v_fmamk_f32 v4, v10, 0x40000000, v11
  v_fmamk_f32 v5, v10, 0x40400000, v11
  v_cos_f32 v6, v4
  v_cos_f32 v7, v5
  v_sin_f32_e64 v8, v4
  v_sin_f32_e64 v9, v5
  v_cvt_pk_bf16_f32 v21, v6, v7
  v_cvt_pk_bf16_f32 v29, v8, v9
  v_xor_b32 v37, s67, v29
  v_fmamk_f32 v4, v10, 0x40800000, v11
  v_fmamk_f32 v5, v10, 0x40a00000, v11
  v_cos_f32 v6, v4
  v_cos_f32 v7, v5
  v_sin_f32_e64 v8, v4
  v_sin_f32_e64 v9, v5
  v_cvt_pk_bf16_f32 v22, v6, v7
  v_cvt_pk_bf16_f32 v30, v8, v9
  v_xor_b32 v38, s67, v30
  v_fmamk_f32 v4, v10, 0x40c00000, v11
  v_fmamk_f32 v5, v10, 0x40e00000, v11
  v_cos_f32 v6, v4
  v_cos_f32 v7, v5
  v_sin_f32_e64 v8, v4
  v_sin_f32_e64 v9, v5
  v_cvt_pk_bf16_f32 v23, v6, v7
  v_cvt_pk_bf16_f32 v31, v8, v9
  v_xor_b32 v39, s67, v31
  s_lshl_b32 s48, s43, 15
  s_lshl_b32 s49, s40, 8
  s_add_u32 s48, s48, s49
  v_lshlrev_b32 v145, 13, v3
  v_lshl_add_u32 v145, v2, 4, v145
  v_add_u32 v145, s48, v145
  v_add_u32 v146, 4096, v145
  v_lshl_add_u32 v147, v3, 5, v2
  v_mul_u32_u24 v147, 288, v147
  s_lshl_b32 s48, s40, 5
  s_add_u32 s48, s48, 114688
  v_add_u32 v147, s48, v147
  s_lshr_b32 s50, s40, 1
  s_mul_i32 s48, s50, 4608
  s_add_u32 s48, s48, 114688
  v_mul_u32_u24 v148, 288, v2
  v_lshl_add_u32 v148, v3, 4, v148
  v_add_u32 v148, s48, v148
  s_and_b32 s51, s40, 1
  s_lshl_b32 s48, s43, 15
  s_lshl_b32 s49, s42, 13
  s_add_u32 s48, s48, s49
  s_lshl_b32 s49, s51, 12
  s_add_u32 s48, s48, s49
  s_lshl_b32 s49, s50, 8
  s_add_u32 s48, s48, s49
  v_lshrrev_b32 v149, 1, v3
  v_lshlrev_b32 v149, 10, v149
  v_and_b32 v4, 1, v3
  v_lshl_add_u32 v149, v4, 9, v149
  v_lshl_add_u32 v149, v2, 4, v149
  v_add_u32 v149, s48, v149
  s_lshl_b32 s48, s43, 11
  s_lshl_b32 s49, s42, 9
  s_add_u32 s48, s48, s49
  s_lshl_b32 s49, s51, 8
  s_add_u32 s48, s48, s49
  s_lshl_b32 s49, s50, 7
  s_add_u32 s48, s48, s49
  v_lshrrev_b32 v150, 5, v1
  v_lshlrev_b32 v150, 6, v150
  v_lshl_add_u32 v150, v2, 2, v150
  v_add_u32 v150, s48, v150
  s_waitcnt vmcnt(4)
  s_waitcnt lgkmcnt(0)
  s_barrier
  s_cmp_eq_u32 s40, 0
  s_cbranch_scc0 B2_NOARR
  s_and_b32 s48, s2, 31
  s_add_u32 s48, s48, 32
  s_lshl_b32 s48, s48, 8
  v_mov_b32 v255, s48
  v_mov_b32 v254, 1
  s_mov_b64 exec, 1
  global_atomic_add v255, v254, s[34:35] sc1
  s_mov_b64 exec, -1
B2_NOARR:
  s_and_b32 s48, s40, 1
  s_lshl_b32 s48, s48, 4
  s_lshl_b32 s49, s42, 5
  s_add_u32 s48, s48, s49
  v_add_u32 v232, s48, v2
  v_cvt_f32_u32 v230, v232
  v_mul_f32 v230, 0x3b000000, v230
  v_lshrrev_b32 v231, 1, v3
  v_lshlrev_b32 v231, 6, v231
  v_and_b32 v224, 1, v3
  v_lshl_add_u32 v231, v224, 3, v231
  v_cvt_f32_u32 v231, v231
  v_mul_f32 v231, v230, v231
  s_add_u32 m0, s70, 10752
  s_mov_b64 exec, s[38:39]
  global_load_lds_dwordx4 v252, s[36:37]
  s_mov_b64 exec, -1
  v_add_u32 v252, 14336, v252
  v_fmamk_f32 v224, v230, 0x3f800000, v231
  v_fmamk_f32 v225, v230, 0x41880000, v231
  v_cos_f32 v226, v224
  v_cos_f32 v227, v225
  v_sin_f32_e64 v228, -v224
  v_sin_f32_e64 v229, -v225
  v_cvt_pk_bf16_f32 v168, v226, v227
  v_cvt_pk_bf16_f32 v200, v228, v229
  s_add_u32 m0, s70, 11648
  s_mov_b64 exec, s[38:39]
  global_load_lds_dwordx4 v252, s[36:37]
  s_mov_b64 exec, -1
  v_add_u32 v252, 14336, v252
  v_fmamk_f32 v224, v230, 0x42040000, v231
  v_fmamk_f32 v225, v230, 0x42440000, v231
  v_cos_f32 v226, v224
  v_cos_f32 v227, v225
  v_sin_f32_e64 v228, -v224
  v_sin_f32_e64 v229, -v225
  v_cvt_pk_bf16_f32 v169, v226, v227
  v_cvt_pk_bf16_f32 v201, v228, v229
  v_fmamk_f32 v224, v230, 0x40a00000, v231
  s_add_u32 m0, s70, 12544
  s_mov_b64 exec, s[38:39]
  global_load_lds_dwordx4 v252, s[36:37]
  s_mov_b64 exec, -1
  v_add_u32 v252, 14336, v252
  v_fmamk_f32 v225, v230, 0x41a80000, v231
  v_cos_f32 v226, v224
  v_cos_f32 v227, v225
  v_sin_f32_e64 v228, -v224
  v_sin_f32_e64 v229, -v225
  v_cvt_pk_bf16_f32 v170, v226, v227
  v_cvt_pk_bf16_f32 v202, v228, v229
  v_fmamk_f32 v224, v230, 0x42140000, v231
  s_add_u32 m0, s70, 13440
  s_mov_b64 exec, s[38:39]
  global_load_lds_dwordx4 v252, s[36:37]
  s_mov_b64 exec, -1
  v_add_u32 v252, 14336, v252
  v_fmamk_f32 v225, v230, 0x42540000, v231
  v_cos_f32 v226, v224
  v_cos_f32 v227, v225
  v_sin_f32_e64 v228, -v224
  v_sin_f32_e64 v229, -v225
  v_cvt_pk_bf16_f32 v171, v226, v227
  v_cvt_pk_bf16_f32 v203, v228, v229
  v_fmamk_f32 v224, v230, 0x40400000, v231
  v_fmamk_f32 v225, v230, 0x41980000, v231
  s_add_u32 m0, s70, 14336
  s_mov_b64 exec, s[38:39]
  global_load_lds_dwordx4 v252, s[36:37]
  s_mov_b64 exec, -1
  v_add_u32 v252, 14336, v252
  v_cos_f32 v226, v224
  v_cos_f32 v227, v225
  v_sin_f32_e64 v228, -v224
  v_sin_f32_e64 v229, -v225
  v_cvt_pk_bf16_f32 v184, v226, v227
  v_cvt_pk_bf16_f32 v216, v228, v229
  v_fmamk_f32 v224, v230, 0x420c0000, v231
  v_fmamk_f32 v225, v230, 0x424c0000, v231
  s_add_u32 m0, s70, 15232
  s_mov_b64 exec, s[38:39]
  global_load_lds_dwordx4 v252, s[36:37]
  s_mov_b64 exec, -1
  v_add_u32 v252, 14336, v252
  v_cos_f32 v226, v224
  v_cos_f32 v227, v225
  v_sin_f32_e64 v228, -v224
  v_sin_f32_e64 v229, -v225
  v_cvt_pk_bf16_f32 v185, v226, v227
  v_cvt_pk_bf16_f32 v217, v228, v229
  v_fmamk_f32 v224, v230, 0x40e00000, v231
  v_fmamk_f32 v225, v230, 0x41b80000, v231
  v_cos_f32 v226, v224
  s_add_u32 m0, s70, 16128
  s_mov_b64 exec, s[38:39]
  global_load_lds_dwordx4 v252, s[36:37]
  s_mov_b64 exec, -1
  v_add_u32 v252, 14336, v252
  v_cos_f32 v227, v225
  v_sin_f32_e64 v228, -v224
  v_sin_f32_e64 v229, -v225
  v_cvt_pk_bf16_f32 v186, v226, v227
  v_cvt_pk_bf16_f32 v218, v228, v229
  v_fmamk_f32 v224, v230, 0x421c0000, v231
  v_fmamk_f32 v225, v230, 0x425c0000, v231
  v_cos_f32 v226, v224
  s_add_u32 m0, s70, 17024
  s_mov_b64 exec, s[38:39]
  global_load_lds_dwordx4 v252, s[36:37]
  s_mov_b64 exec, -1
  v_add_u32 v252, 14336, v252
  v_cos_f32 v227, v225
  v_sin_f32_e64 v228, -v224
  v_sin_f32_e64 v229, -v225
  v_cvt_pk_bf16_f32 v187, v226, v227
  v_cvt_pk_bf16_f32 v219, v228, v229
  v_bfe_u32 v224, v232, 1, 1
  v_mul_u32_u24 v233, 0x8000, v224
  v_lshl_or_b32 v233, v233, 16, v233
  v_add_u32 v224, 1, v232
  s_add_u32 m0, s70, 17920
  s_mov_b64 exec, s[38:39]
  global_load_lds_dwordx4 v252, s[36:37]
  s_mov_b64 exec, -1
  v_add_u32 v252, 14336, v252
  v_bfe_u32 v224, v224, 1, 1
  v_mul_u32_u24 v234, 0x8000, v224
  v_lshl_or_b32 v234, v234, 16, v234
  v_and_b32 v224, 1, v232
  v_cmp_eq_u32 vcc, 1, v224
  s_nop 1
  v_cndmask_b32 v172, v168, v200, vcc
  v_cndmask_b32 v204, v200, v168, vcc
  v_xor_b32 v172, v233, v172
  v_xor_b32 v204, v234, v204
  v_cndmask_b32 v173, v169, v201, vcc
  v_cndmask_b32 v205, v201, v169, vcc
  v_xor_b32 v173, v233, v173
  s_add_u32 m0, s70, 18816
  s_mov_b64 exec, s[38:39]
  global_load_lds_dwordx4 v252, s[36:37]
  s_mov_b64 exec, -1
  v_add_u32 v252, 14336, v252
  v_xor_b32 v205, v234, v205
  v_cndmask_b32 v174, v170, v202, vcc
  v_cndmask_b32 v206, v202, v170, vcc
  v_xor_b32 v174, v233, v174
  v_xor_b32 v206, v234, v206
  v_cndmask_b32 v175, v171, v203, vcc
  v_cndmask_b32 v207, v203, v171, vcc
  v_xor_b32 v175, v233, v175
  v_xor_b32 v207, v234, v207
  v_cndmask_b32 v188, v184, v216, vcc
  v_cndmask_b32 v220, v216, v184, vcc
  v_xor_b32 v188, v233, v188
  v_xor_b32 v220, v234, v220
  s_add_u32 m0, s70, 19712
  s_mov_b64 exec, s[38:39]
  global_load_lds_dwordx4 v252, s[36:37]
  s_mov_b64 exec, -1
  v_add_u32 v252, 14336, v252
  v_cndmask_b32 v189, v185, v217, vcc
  v_cndmask_b32 v221, v217, v185, vcc
  v_xor_b32 v189, v233, v189
  v_xor_b32 v221, v234, v221
  v_cndmask_b32 v190, v186, v218, vcc
  v_cndmask_b32 v222, v218, v186, vcc
  v_xor_b32 v190, v233, v190
  v_xor_b32 v222, v234, v222
  v_cndmask_b32 v191, v187, v219, vcc
  v_cndmask_b32 v223, v219, v187, vcc
  v_xor_b32 v191, v233, v191
  v_xor_b32 v223, v234, v223
  s_add_u32 m0, s70, 20608
  s_mov_b64 exec, s[38:39]
  global_load_lds_dwordx4 v252, s[36:37]
  s_mov_b64 exec, -1
  v_add_u32 v252, 14336, v252
  s_add_u32 m0, s70, 21504
  s_mov_b64 exec, s[38:39]
  global_load_lds_dwordx4 v252, s[36:37]
  s_mov_b64 exec, -1
  v_add_u32 v252, 14336, v252
  s_add_u32 m0, s70, 22400
  s_mov_b64 exec, s[38:39]
  global_load_lds_dwordx4 v252, s[36:37]
  s_mov_b64 exec, -1
  v_add_u32 v252, 14336, v252
  s_add_u32 m0, s70, 23296
  s_mov_b64 exec, s[38:39]
  global_load_lds_dwordx4 v252, s[36:37]
  s_mov_b64 exec, -1
  v_add_u32 v252, 14336, v252
  s_add_u32 m0, s70, 24192
  s_mov_b64 exec, s[38:39]
  global_load_lds_dwordx4 v252, s[36:37]
  s_mov_b64 exec, -1
  v_add_u32 v252, 14336, v252
  v_mul_u32_u24 v152, 896, v3
  v_bfe_u32 v154, v1, 2, 2
  v_lshl_add_u32 v153, v154, 5, v152
  v_lshl_add_u32 v152, v154, 6, v152
  v_and_b32 v154, 3, v1
  v_lshl_add_u32 v152, v154, 3, v152
  v_lshl_add_u32 v153, v154, 3, v153
  s_lshr_b32 s48, s40, 1
  s_lshl_b32 s48, s48, 8
  s_and_b32 s49, s40, 1
  s_lshl_b32 s49, s49, 5
  s_add_u32 s48, s48, s49
  s_add_u32 s49, s49, 512
  v_add_u32 v154, s49, v152
  v_add_u32 v153, 768, v153
  s_cmp_lt_u32 s40, 2
  s_cselect_b64 vcc, -1, 0
  v_cndmask_b32 v153, v153, v154, vcc
  v_add_u32 v152, s48, v152
  v_add_u32 v154, 57344, v152
  v_add_u32 v155, 57344, v153
  s_lshl_b32 s48, s40, 6
  s_add_u32 s48, s48, 162816
  s_add_u32 s49, s40, 4
  s_min_u32 s49, s49, 6
  s_lshl_b32 s49, s49, 6
  s_add_u32 s49, s49, 162816
  v_lshlrev_b32 v156, 4, v3
  v_add_u32 v157, s49, v156
  v_add_u32 v156, s48, v156
  s_getpc_b64 s[50:51]
L_PF1:
  v_lshlrev_b32 v224, 7, v0
  v_add_u32 v224, L_P3CODE-L_PF1, v224
  v_min_u32 v224, L_P4CODE-L_PF1, v224
  global_load_dword v225, v224, s[50:51]
  s_cmp_eq_u32 s40, 0
  s_cbranch_scc0 B2_NOPOLL
  s_mov_b32 s48, 8192
  v_min_u32 v255, 31, v1
  v_lshlrev_b32 v255, 8, v255
  v_add_u32 v255, s48, v255
  s_mov_b32 s71, 0
  s_nop 0
B2_POLL:
  s_add_u32 s71, s71, 1
  s_cmp_gt_u32 s71, 0x100000
  s_cbranch_scc1 L_END
  global_load_dword v254, v255, s[34:35] sc1
  s_waitcnt vmcnt(0)
  v_cmp_le_u32 vcc, 8, v254
  s_nop 3
  s_cmp_eq_u64 vcc, exec
  s_cbranch_scc0 B2_POLL
B2_NOPOLL:
  s_waitcnt vmcnt(1)
  s_barrier
L_P3CODE:
  global_load_dwordx4 v[40:43], v145, s[26:27] offset:0 sc1
  global_load_dwordx4 v[44:47], v145, s[26:27] offset:1024 sc1
  global_load_dwordx4 v[48:51], v145, s[26:27] offset:2048 sc1
  global_load_dwordx4 v[52:55], v145, s[26:27] offset:3072 sc1
  global_load_dwordx4 v[56:59], v146, s[26:27] offset:0 sc1
  global_load_dwordx4 v[60:63], v146, s[26:27] offset:1024 sc1
  global_load_dwordx4 v[64:67], v146, s[26:27] offset:2048 sc1
  global_load_dwordx4 v[68:71], v146, s[26:27] offset:3072 sc1
  s_add_u32 m0, s70, 25088
  s_mov_b64 exec, s[38:39]
  global_load_lds_dwordx4 v252, s[36:37]
  s_mov_b64 exec, -1
  v_add_u32 v252, 14336, v252
  s_add_u32 m0, s70, 25984
  s_mov_b64 exec, s[38:39]
  global_load_lds_dwordx4 v252, s[36:37]
  s_mov_b64 exec, -1
  v_add_u32 v252, 14336, v252
  s_add_u32 m0, s70, 26880
  s_mov_b64 exec, s[38:39]
  global_load_lds_dwordx4 v252, s[36:37]
  s_mov_b64 exec, -1
  v_add_u32 v252, 14336, v252
  s_add_u32 m0, s70, 27776
  s_mov_b64 exec, s[38:39]
  global_load_lds_dwordx4 v252, s[36:37]
  s_mov_b64 exec, -1
  v_add_u32 v252, 14336, v252
  s_waitcnt vmcnt(10)
  v_perm_b32 v72, v44, v40, s65
  v_perm_b32 v88, v44, v40, s66
  v_perm_b32 v76, v45, v41, s65
  v_perm_b32 v92, v45, v41, s66
  v_perm_b32 v80, v46, v42, s65
  v_perm_b32 v96, v46, v42, s66
  v_perm_b32 v84, v47, v43, s65
  v_perm_b32 v100, v47, v43, s66
  s_waitcnt vmcnt(8)
  v_perm_b32 v73, v52, v48, s65
  v_perm_b32 v89, v52, v48, s66
  v_perm_b32 v77, v53, v49, s65
  v_perm_b32 v93, v53, v49, s66
  v_perm_b32 v81, v54, v50, s65
  v_perm_b32 v97, v54, v50, s66
  v_perm_b32 v85, v55, v51, s65
  v_perm_b32 v101, v55, v51, s66
  s_waitcnt vmcnt(6)
  v_perm_b32 v74, v60, v56, s65
  v_perm_b32 v90, v60, v56, s66
  v_perm_b32 v78, v61, v57, s65
  v_perm_b32 v94, v61, v57, s66
  v_perm_b32 v82, v62, v58, s65
  v_perm_b32 v98, v62, v58, s66
  v_perm_b32 v86, v63, v59, s65
  v_perm_b32 v102, v63, v59, s66
  s_waitcnt vmcnt(4)
  v_perm_b32 v75, v68, v64, s65
  v_perm_b32 v91, v68, v64, s66
  v_perm_b32 v79, v69, v65, s65
  v_perm_b32 v95, v69, v65, s66
  v_perm_b32 v83, v70, v66, s65
  v_perm_b32 v99, v70, v66, s66
  v_perm_b32 v87, v71, v67, s65
  v_perm_b32 v103, v71, v67, s66
  v_mfma_f32_16x16x32_bf16 v[104:107], v[72:75], v[16:19], 0
  v_mfma_f32_16x16x32_bf16 v[120:123], v[72:75], v[24:27], 0
  v_mfma_f32_16x16x32_bf16 v[104:107], v[88:91], v[32:35], v[104:107]
  v_mfma_f32_16x16x32_bf16 v[120:123], v[88:91], v[16:19], v[120:123]
  global_load_dwordx4 a[0:3], v253, s[68:69] offset:0 sc1
  v_mfma_f32_16x16x32_bf16 v[108:111], v[76:79], v[16:19], 0
  v_mfma_f32_16x16x32_bf16 v[124:127], v[76:79], v[24:27], 0
  v_mfma_f32_16x16x32_bf16 v[108:111], v[92:95], v[32:35], v[108:111]
  v_mfma_f32_16x16x32_bf16 v[124:127], v[92:95], v[16:19], v[124:127]
  global_load_dwordx4 a[4:7], v253, s[68:69] offset:1024 sc1
  v_mfma_f32_16x16x32_bf16 v[112:115], v[80:83], v[16:19], 0
  v_mfma_f32_16x16x32_bf16 v[128:131], v[80:83], v[24:27], 0
  v_mfma_f32_16x16x32_bf16 v[112:115], v[96:99], v[32:35], v[112:115]
  v_mfma_f32_16x16x32_bf16 v[128:131], v[96:99], v[16:19], v[128:131]
  global_load_dwordx4 a[8:11], v253, s[68:69] offset:2048 sc1
  v_mfma_f32_16x16x32_bf16 v[116:119], v[84:87], v[16:19], 0
  v_mfma_f32_16x16x32_bf16 v[132:135], v[84:87], v[24:27], 0
  v_mfma_f32_16x16x32_bf16 v[116:119], v[100:103], v[32:35], v[116:119]
  v_mfma_f32_16x16x32_bf16 v[132:135], v[100:103], v[16:19], v[132:135]
  global_load_dwordx4 a[12:15], v253, s[68:69] offset:3072 sc1
  v_mfma_f32_16x16x32_bf16 v[40:43], v[72:75], v[20:23], 0
  v_add_u32 v253, 4096, v253
  global_load_dwordx4 a[16:19], v253, s[68:69] offset:0 sc1
  v_mfma_f32_16x16x32_bf16 v[56:59], v[72:75], v[28:31], 0
  v_mfma_f32_16x16x32_bf16 v[40:43], v[88:91], v[36:39], v[40:43]
  v_cvt_pk_bf16_f32 v224, v104, v105
  v_cvt_pk_bf16_f32 v225, v106, v107
  v_mfma_f32_16x16x32_bf16 v[56:59], v[88:91], v[20:23], v[56:59]
  v_cvt_pk_bf16_f32 v226, v108, v109
  v_mfma_f32_16x16x32_bf16 v[44:47], v[76:79], v[20:23], 0
  global_load_dwordx4 a[20:23], v253, s[68:69] offset:1024 sc1
  v_cvt_pk_bf16_f32 v227, v110, v111
  v_cvt_pk_bf16_f32 v228, v112, v113
  v_mfma_f32_16x16x32_bf16 v[60:63], v[76:79], v[28:31], 0
  v_cvt_pk_bf16_f32 v229, v114, v115
  v_cvt_pk_bf16_f32 v230, v116, v117
  v_mfma_f32_16x16x32_bf16 v[44:47], v[92:95], v[36:39], v[44:47]
  v_cvt_pk_bf16_f32 v231, v118, v119
  v_mfma_f32_16x16x32_bf16 v[60:63], v[92:95], v[20:23], v[60:63]
  v_mfma_f32_16x16x32_bf16 v[48:51], v[80:83], v[20:23], 0
  global_load_dwordx4 a[24:27], v253, s[68:69] offset:2048 sc1
  ds_write_b128 v147, v[224:227] offset:0
  v_mfma_f32_16x16x32_bf16 v[64:67], v[80:83], v[28:31], 0
  ds_write_b128 v147, v[228:231] offset:16
  v_cvt_pk_bf16_f32 v232, v120, v121
  v_cvt_pk_bf16_f32 v233, v122, v123
  v_mfma_f32_16x16x32_bf16 v[48:51], v[96:99], v[36:39], v[48:51]
  v_cvt_pk_bf16_f32 v234, v124, v125
  v_mfma_f32_16x16x32_bf16 v[64:67], v[96:99], v[20:23], v[64:67]
  v_cvt_pk_bf16_f32 v235, v126, v127
  v_cvt_pk_bf16_f32 v236, v128, v129
  v_mfma_f32_16x16x32_bf16 v[52:55], v[84:87], v[20:23], 0
  global_load_dwordx4 a[28:31], v253, s[68:69] offset:3072 sc1
  v_cvt_pk_bf16_f32 v237, v130, v131
  v_cvt_pk_bf16_f32 v238, v132, v133
  v_mfma_f32_16x16x32_bf16 v[68:71], v[84:87], v[28:31], 0
  v_cvt_pk_bf16_f32 v239, v134, v135
  v_mfma_f32_16x16x32_bf16 v[52:55], v[100:103], v[36:39], v[52:55]
  v_mfma_f32_16x16x32_bf16 v[68:71], v[100:103], v[20:23], v[68:71]
  ds_write_b128 v147, v[232:235] offset:128
  ds_write_b128 v147, v[236:239] offset:144
  v_cvt_pk_bf16_f32 v224, v40, v41
  v_cvt_pk_bf16_f32 v225, v42, v43
  v_cvt_pk_bf16_f32 v226, v44, v45
  v_cvt_pk_bf16_f32 v227, v46, v47
  v_cvt_pk_bf16_f32 v228, v48, v49
  v_cvt_pk_bf16_f32 v229, v50, v51
  v_cvt_pk_bf16_f32 v230, v52, v53
  v_cvt_pk_bf16_f32 v231, v54, v55
  ds_write_b128 v147, v[224:227] offset:4608
  ds_write_b128 v147, v[228:231] offset:4624
  v_cvt_pk_bf16_f32 v232, v56, v57
  v_cvt_pk_bf16_f32 v233, v58, v59
  v_cvt_pk_bf16_f32 v234, v60, v61
  v_cvt_pk_bf16_f32 v235, v62, v63
  v_cvt_pk_bf16_f32 v236, v64, v65
  v_cvt_pk_bf16_f32 v237, v66, v67
  v_cvt_pk_bf16_f32 v238, v68, v69
  v_cvt_pk_bf16_f32 v239, v70, v71
  ds_write_b128 v147, v[232:235] offset:4736
  ds_write_b128 v147, v[236:239] offset:4752
  s_waitcnt lgkmcnt(0)
  s_barrier
  ds_read_b128 v[40:43], v148 offset:0
  ds_read_b128 v[44:47], v148 offset:64
  ds_read_b128 v[48:51], v148 offset:128
  ds_read_b128 v[52:55], v148 offset:192
  ds_read_b128 v[56:59], v148 offset:18432
  ds_read_b128 v[60:63], v148 offset:18496
  ds_read_b128 v[64:67], v148 offset:18560
  ds_read_b128 v[68:71], v148 offset:18624
  ds_read_b128 v[104:107], v148 offset:9216
  ds_read_b128 v[108:111], v148 offset:9280
  ds_read_b128 v[112:115], v148 offset:9344
  ds_read_b128 v[116:119], v148 offset:9408
  ds_read_b128 v[120:123], v148 offset:27648
  ds_read_b128 v[124:127], v148 offset:27712
  ds_read_b128 v[128:131], v148 offset:27776
  ds_read_b128 v[132:135], v148 offset:27840
  s_waitcnt lgkmcnt(15)
  v_mfma_f32_16x16x32_bf16 v[72:75], v[160:163], v[40:43], 0
  s_waitcnt lgkmcnt(14)
  v_mfma_f32_16x16x32_bf16 v[72:75], v[164:167], v[44:47], v[72:75]
  v_add_u32 v253, 4096, v253
  global_load_dwordx4 a[32:35], v253, s[68:69] offset:0 sc1
  s_waitcnt lgkmcnt(13)
  v_mfma_f32_16x16x32_bf16 v[72:75], v[192:195], v[48:51], v[72:75]
  s_waitcnt lgkmcnt(12)
  v_mfma_f32_16x16x32_bf16 v[72:75], v[196:199], v[52:55], v[72:75]
  global_load_dwordx4 a[36:39], v253, s[68:69] offset:1024 sc1
  s_waitcnt lgkmcnt(11)
  v_mfma_f32_16x16x32_bf16 v[76:79], v[176:179], v[56:59], 0
  s_waitcnt lgkmcnt(10)
  v_mfma_f32_16x16x32_bf16 v[76:79], v[180:183], v[60:63], v[76:79]
  global_load_dwordx4 a[40:43], v253, s[68:69] offset:2048 sc1
  s_waitcnt lgkmcnt(9)
  v_mfma_f32_16x16x32_bf16 v[76:79], v[208:211], v[64:67], v[76:79]
  s_waitcnt lgkmcnt(8)
  v_mfma_f32_16x16x32_bf16 v[76:79], v[212:215], v[68:71], v[76:79]
  global_load_dwordx4 a[44:47], v253, s[68:69] offset:3072 sc1
  s_waitcnt lgkmcnt(7)
  v_mfma_f32_16x16x32_bf16 v[80:83], v[168:171], v[104:107], 0
  v_mfma_f32_16x16x32_bf16 v[88:91], v[200:203], v[104:107], 0
  v_add_u32 v253, 4096, v253
  global_load_dwordx4 a[48:51], v253, s[68:69] offset:0 sc1
  s_waitcnt lgkmcnt(6)
  v_mfma_f32_16x16x32_bf16 v[80:83], v[172:175], v[108:111], v[80:83]
  v_mfma_f32_16x16x32_bf16 v[88:91], v[204:207], v[108:111], v[88:91]
  global_load_dwordx4 a[52:55], v253, s[68:69] offset:1024 sc1
  s_waitcnt lgkmcnt(5)
  v_mfma_f32_16x16x32_bf16 v[84:87], v[168:171], v[112:115], 0
  v_mfma_f32_16x16x32_bf16 v[80:83], v[200:203], v[112:115], v[80:83]
  global_load_dwordx4 a[56:59], v253, s[68:69] offset:2048 sc1
  s_waitcnt lgkmcnt(4)
  v_mfma_f32_16x16x32_bf16 v[84:87], v[172:175], v[116:119], v[84:87]
  v_mfma_f32_16x16x32_bf16 v[80:83], v[204:207], v[116:119], v[80:83]
  global_load_dwordx4 a[60:63], v253, s[68:69] offset:3072 sc1
  s_waitcnt lgkmcnt(3)
  v_mfma_f32_16x16x32_bf16 v[80:83], v[184:187], v[120:123], v[80:83]
  v_mfma_f32_16x16x32_bf16 v[84:87], v[216:219], v[120:123], v[84:87]
  v_add_u32 v253, 4096, v253
  global_load_dwordx4 a[64:67], v253, s[68:69] offset:0 sc1
  s_waitcnt lgkmcnt(2)
  v_mfma_f32_16x16x32_bf16 v[80:83], v[188:191], v[124:127], v[80:83]
  v_mfma_f32_16x16x32_bf16 v[84:87], v[220:223], v[124:127], v[84:87]
  global_load_dwordx4 a[68:71], v253, s[68:69] offset:1024 sc1
  s_waitcnt lgkmcnt(1)
  v_mfma_f32_16x16x32_bf16 v[80:83], v[216:219], v[128:131], v[80:83]
  v_mfma_f32_16x16x32_bf16 v[88:91], v[184:187], v[128:131], v[88:91]
  global_load_dwordx4 a[72:75], v253, s[68:69] offset:2048 sc1
  s_waitcnt lgkmcnt(0)
  v_mfma_f32_16x16x32_bf16 v[80:83], v[220:223], v[132:135], v[80:83]
  v_mfma_f32_16x16x32_bf16 v[88:91], v[188:191], v[132:135], v[88:91]
  global_load_dwordx4 a[76:79], v253, s[68:69] offset:3072 sc1
  v_add_u32 v253, 4096, v253
  global_load_dwordx4 a[80:83], v253, s[68:69] offset:0 sc1
  global_load_dwordx4 a[84:87], v253, s[68:69] offset:1024 sc1
  global_load_dwordx4 a[88:91], v253, s[68:69] offset:2048 sc1
  global_load_dwordx4 a[92:95], v253, s[68:69] offset:3072 sc1
  v_add_u32 v253, 4096, v253
  global_load_dwordx4 a[96:99], v253, s[68:69] offset:0 sc1
  global_load_dwordx4 a[100:103], v253, s[68:69] offset:1024 sc1
  global_load_dwordx4 a[104:107], v253, s[68:69] offset:2048 sc1
  global_load_dwordx4 a[108:111], v253, s[68:69] offset:3072 sc1
  v_lshlrev_b32 v16, 16, v136
  v_and_b32 v17, 0xffff0000, v136
  v_lshlrev_b32 v18, 16, v137
  v_and_b32 v19, 0xffff0000, v137
  v_lshlrev_b32 v20, 16, v138
  v_and_b32 v21, 0xffff0000, v138
  v_lshlrev_b32 v22, 16, v139
  v_and_b32 v23, 0xffff0000, v139
  v_lshlrev_b32 v24, 16, v140
  v_and_b32 v25, 0xffff0000, v140
  v_lshlrev_b32 v26, 16, v141
  v_and_b32 v27, 0xffff0000, v141
  v_lshlrev_b32 v28, 16, v142
  v_and_b32 v29, 0xffff0000, v142
  v_lshlrev_b32 v30, 16, v143
  v_and_b32 v31, 0xffff0000, v143
  s_mov_b32 s48, 0x36000000
  v_add_f32 v40, v72, v76
  v_sub_f32 v44, v72, v76
  v_add_f32 v41, v73, v77
  v_sub_f32 v45, v73, v77
  v_add_f32 v42, v74, v78
  v_sub_f32 v46, v74, v78
  v_add_f32 v43, v75, v79
  v_sub_f32 v47, v75, v79
  v_sub_f32 v48, v84, v88
  v_sub_f32 v49, v85, v89
  v_sub_f32 v50, v86, v90
  v_sub_f32 v51, v87, v91
  v_add_f32 v52, v40, v80
  v_sub_f32 v56, v44, v48
  v_sub_f32 v60, v40, v80
  v_add_f32 v64, v44, v48
  v_add_f32 v53, v41, v81
  v_sub_f32 v57, v45, v49
  v_sub_f32 v61, v41, v81
  v_add_f32 v65, v45, v49
  v_add_f32 v54, v42, v82
  v_sub_f32 v58, v46, v50
  v_sub_f32 v62, v42, v82
  v_add_f32 v66, v46, v50
  v_add_f32 v55, v43, v83
  v_sub_f32 v59, v47, v51
  v_sub_f32 v63, v43, v83
  v_add_f32 v67, v47, v51
  v_fma_f32 v16, v52, s48, v16
  v_fma_f32 v17, v53, s48, v17
  v_fma_f32 v18, v54, s48, v18
  v_fma_f32 v19, v55, s48, v19
  v_fma_f32 v20, v56, s48, v20
  v_fma_f32 v21, v57, s48, v21
  v_fma_f32 v22, v58, s48, v22
  v_fma_f32 v23, v59, s48, v23
  v_fma_f32 v24, v60, s48, v24
  v_fma_f32 v25, v61, s48, v25
  v_fma_f32 v26, v62, s48, v26
  v_fma_f32 v27, v63, s48, v27
  v_fma_f32 v28, v64, s48, v28
  v_fma_f32 v29, v65, s48, v29
  v_fma_f32 v30, v66, s48, v30
  v_fma_f32 v31, v67, s48, v31
  v_cvt_pk_bf16_f32 v104, v16, v17
  v_cvt_pk_bf16_f32 v105, v18, v19
  v_cvt_pk_bf16_f32 v106, v20, v21
  v_cvt_pk_bf16_f32 v107, v22, v23
  v_cvt_pk_bf16_f32 v108, v24, v25
  v_cvt_pk_bf16_f32 v109, v26, v27
  v_cvt_pk_bf16_f32 v110, v28, v29
  v_cvt_pk_bf16_f32 v111, v30, v31
  global_store_dwordx4 v149, v[104:107], s[28:29] offset:0 sc1
  global_store_dwordx4 v149, v[108:111], s[28:29] offset:2048 sc1
  v_mov_b32 v6, 0
  v_mov_b32 v7, 0
  v_dot2c_f32_bf16 v6, s64, v104
  v_dot2c_f32_bf16 v7, v104, v104
  v_dot2c_f32_bf16 v6, s64, v105
  v_dot2c_f32_bf16 v7, v105, v105
  v_dot2c_f32_bf16 v6, s64, v106
  v_dot2c_f32_bf16 v7, v106, v106
  v_dot2c_f32_bf16 v6, s64, v107
  v_dot2c_f32_bf16 v7, v107, v107
  v_dot2c_f32_bf16 v6, s64, v108
  v_dot2c_f32_bf16 v7, v108, v108
  v_dot2c_f32_bf16 v6, s64, v109
  v_dot2c_f32_bf16 v7, v109, v109
  v_dot2c_f32_bf16 v6, s64, v110
  v_dot2c_f32_bf16 v7, v110, v110
  v_dot2c_f32_bf16 v6, s64, v111
  v_dot2c_f32_bf16 v7, v111, v111
  s_nop 2
  v_permlane32_swap_b32 v6, v7
  v_add_f32 v6, v6, v7
  v_mov_b32 v7, v6
  s_nop 1
  v_permlane16_swap_b32 v6, v7
  v_add_f32 v6, v6, v7
  global_store_dword v150, v6, s[30:31] sc1
  s_waitcnt vmcnt(31)
  s_barrier
  v_mov_b32 v8, s64
  v_mov_b32 v9, s64
  v_mov_b32 v10, s64
  v_mov_b32 v11, s64
  ds_read_b64_tr_b16 v[20:21], v152 offset:0
  ds_read_b64_tr_b16 v[22:23], v152 offset:3584
  ds_read_b64_tr_b16 v[24:25], v153 offset:0
  ds_read_b64_tr_b16 v[26:27], v153 offset:3584
  ds_read_b64_tr_b16 v[28:29], v152 offset:7168
  ds_read_b64_tr_b16 v[30:31], v152 offset:10752
  ds_read_b64_tr_b16 v[32:33], v153 offset:7168
  ds_read_b64_tr_b16 v[34:35], v153 offset:10752
  ds_read_b64_tr_b16 v[36:37], v152 offset:14336
  ds_read_b64_tr_b16 v[38:39], v152 offset:17920
  ds_read_b64_tr_b16 v[40:41], v153 offset:14336
  ds_read_b64_tr_b16 v[42:43], v153 offset:17920
  ds_read_b64_tr_b16 v[44:45], v152 offset:21504
  ds_read_b64_tr_b16 v[46:47], v152 offset:25088
  s_waitcnt lgkmcnt(10)
  v_mfma_f32_16x16x32_bf16 v[12:15], v[20:23], v[8:11], 0
  ds_read_b64_tr_b16 v[48:49], v153 offset:21504
  ds_read_b64_tr_b16 v[50:51], v153 offset:25088
  v_mfma_f32_16x16x32_bf16 v[16:19], v[24:27], v[8:11], 0
  ds_read_b64_tr_b16 v[20:21], v152 offset:28672
  ds_read_b64_tr_b16 v[22:23], v152 offset:32256
  s_waitcnt lgkmcnt(10)
  v_mfma_f32_16x16x32_bf16 v[12:15], v[28:31], v[8:11], v[12:15]
  ds_read_b64_tr_b16 v[24:25], v153 offset:28672
  ds_read_b64_tr_b16 v[26:27], v153 offset:32256
  v_mfma_f32_16x16x32_bf16 v[16:19], v[32:35], v[8:11], v[16:19]
  ds_read_b64_tr_b16 v[28:29], v152 offset:35840
  ds_read_b64_tr_b16 v[30:31], v152 offset:39424
  s_waitcnt lgkmcnt(10)
  v_mfma_f32_16x16x32_bf16 v[12:15], v[36:39], v[8:11], v[12:15]
  ds_read_b64_tr_b16 v[32:33], v153 offset:35840
  ds_read_b64_tr_b16 v[34:35], v153 offset:39424
  v_mfma_f32_16x16x32_bf16 v[16:19], v[40:43], v[8:11], v[16:19]
  ds_read_b64_tr_b16 v[36:37], v152 offset:43008
  ds_read_b64_tr_b16 v[38:39], v152 offset:46592
  s_waitcnt lgkmcnt(10)
  v_mfma_f32_16x16x32_bf16 v[12:15], v[44:47], v[8:11], v[12:15]
  ds_read_b64_tr_b16 v[40:41], v153 offset:43008
  ds_read_b64_tr_b16 v[42:43], v153 offset:46592
  v_mfma_f32_16x16x32_bf16 v[16:19], v[48:51], v[8:11], v[16:19]
  ds_read_b64_tr_b16 v[44:45], v152 offset:50176
  ds_read_b64_tr_b16 v[46:47], v152 offset:53760
  s_waitcnt lgkmcnt(10)
  v_mfma_f32_16x16x32_bf16 v[12:15], v[20:23], v[8:11], v[12:15]
  ds_read_b64_tr_b16 v[48:49], v153 offset:50176
  ds_read_b64_tr_b16 v[50:51], v153 offset:53760
  v_mfma_f32_16x16x32_bf16 v[16:19], v[24:27], v[8:11], v[16:19]
  ds_read_b64_tr_b16 v[20:21], v154 offset:0
  ds_read_b64_tr_b16 v[22:23], v154 offset:3584
  s_waitcnt lgkmcnt(10)
  v_mfma_f32_16x16x32_bf16 v[12:15], v[28:31], v[8:11], v[12:15]
  ds_read_b64_tr_b16 v[24:25], v155 offset:0
  ds_read_b64_tr_b16 v[26:27], v155 offset:3584
  v_mfma_f32_16x16x32_bf16 v[16:19], v[32:35], v[8:11], v[16:19]
  ds_read_b64_tr_b16 v[28:29], v154 offset:7168
  ds_read_b64_tr_b16 v[30:31], v154 offset:10752
  s_waitcnt lgkmcnt(10)
  v_mfma_f32_16x16x32_bf16 v[12:15], v[36:39], v[8:11], v[12:15]
  ds_read_b64_tr_b16 v[32:33], v155 offset:7168
  ds_read_b64_tr_b16 v[34:35], v155 offset:10752
  v_mfma_f32_16x16x32_bf16 v[16:19], v[40:43], v[8:11], v[16:19]
  ds_read_b64_tr_b16 v[36:37], v154 offset:14336
  ds_read_b64_tr_b16 v[38:39], v154 offset:17920
  s_waitcnt lgkmcnt(10)
  v_mfma_f32_16x16x32_bf16 v[12:15], v[44:47], v[8:11], v[12:15]
  ds_read_b64_tr_b16 v[40:41], v155 offset:14336
  ds_read_b64_tr_b16 v[42:43], v155 offset:17920
  v_mfma_f32_16x16x32_bf16 v[16:19], v[48:51], v[8:11], v[16:19]
  ds_read_b64_tr_b16 v[44:45], v154 offset:21504
  ds_read_b64_tr_b16 v[46:47], v154 offset:25088
  s_waitcnt lgkmcnt(10)
  v_mfma_f32_16x16x32_bf16 v[12:15], v[20:23], v[8:11], v[12:15]
  ds_read_b64_tr_b16 v[48:49], v155 offset:21504
  ds_read_b64_tr_b16 v[50:51], v155 offset:25088
  v_mfma_f32_16x16x32_bf16 v[16:19], v[24:27], v[8:11], v[16:19]
  ds_read_b64_tr_b16 v[20:21], v154 offset:28672
  ds_read_b64_tr_b16 v[22:23], v154 offset:32256
  s_waitcnt lgkmcnt(10)
  v_mfma_f32_16x16x32_bf16 v[12:15], v[28:31], v[8:11], v[12:15]
  ds_read_b64_tr_b16 v[24:25], v155 offset:28672
  ds_read_b64_tr_b16 v[26:27], v155 offset:32256
  v_mfma_f32_16x16x32_bf16 v[16:19], v[32:35], v[8:11], v[16:19]
  ds_read_b64_tr_b16 v[28:29], v154 offset:35840
  ds_read_b64_tr_b16 v[30:31], v154 offset:39424
  s_waitcnt lgkmcnt(10)
  v_mfma_f32_16x16x32_bf16 v[12:15], v[36:39], v[8:11], v[12:15]
  ds_read_b64_tr_b16 v[32:33], v155 offset:35840
  ds_read_b64_tr_b16 v[34:35], v155 offset:39424
  v_mfma_f32_16x16x32_bf16 v[16:19], v[40:43], v[8:11], v[16:19]
  ds_read_b64_tr_b16 v[36:37], v154 offset:43008
  ds_read_b64_tr_b16 v[38:39], v154 offset:46592
  s_waitcnt lgkmcnt(10)
  v_mfma_f32_16x16x32_bf16 v[12:15], v[44:47], v[8:11], v[12:15]
  ds_read_b64_tr_b16 v[40:41], v155 offset:43008
  ds_read_b64_tr_b16 v[42:43], v155 offset:46592
  v_mfma_f32_16x16x32_bf16 v[16:19], v[48:51], v[8:11], v[16:19]
  ds_read_b64_tr_b16 v[44:45], v154 offset:50176
  ds_read_b64_tr_b16 v[46:47], v154 offset:53760
  s_waitcnt lgkmcnt(10)
  v_mfma_f32_16x16x32_bf16 v[12:15], v[20:23], v[8:11], v[12:15]
  ds_read_b64_tr_b16 v[48:49], v155 offset:50176
  ds_read_b64_tr_b16 v[50:51], v155 offset:53760
  v_mfma_f32_16x16x32_bf16 v[16:19], v[24:27], v[8:11], v[16:19]
  s_waitcnt lgkmcnt(10)
  v_mfma_f32_16x16x32_bf16 v[12:15], v[28:31], v[8:11], v[12:15]
  s_waitcnt lgkmcnt(8)
  v_mfma_f32_16x16x32_bf16 v[16:19], v[32:35], v[8:11], v[16:19]
  s_waitcnt lgkmcnt(6)
  v_mfma_f32_16x16x32_bf16 v[12:15], v[36:39], v[8:11], v[12:15]
  s_waitcnt lgkmcnt(4)
  v_mfma_f32_16x16x32_bf16 v[16:19], v[40:43], v[8:11], v[16:19]
  s_waitcnt lgkmcnt(2)
  v_mfma_f32_16x16x32_bf16 v[12:15], v[44:47], v[8:11], v[12:15]
  s_waitcnt lgkmcnt(0)
  v_mfma_f32_16x16x32_bf16 v[16:19], v[48:51], v[8:11], v[16:19]
  v_cmp_eq_u32 vcc, 0, v2
  s_nop 3
  s_and_saveexec_b64 s[50:51], vcc
  ds_write_b128 v156, v[12:15]
  s_nop 0
  ds_write_b128 v157, v[16:19]
  s_mov_b64 exec, s[50:51]
  v_lshrrev_b32 v228, 5, v1
  v_mul_u32_u24 v4, 896, v228
  v_bfe_u32 v228, v1, 2, 2
  v_lshl_add_u32 v6, v228, 5, v4
  v_lshl_add_u32 v4, v228, 6, v4
  v_and_b32 v228, 3, v1
  v_lshl_add_u32 v4, v228, 3, v4
  v_lshl_add_u32 v6, v228, 3, v6
  v_bfe_u32 v228, v1, 4, 1
  v_lshl_add_u32 v4, v228, 5, v4
  v_add_u32 v5, 57344, v4
  v_add_u32 v7, 57344, v6
  s_mul_i32 s48, s44, 224
  v_and_b32 v228, 31, v1
  v_add_u32 v229, 0, v228
  v_min_u32 v229, 111, v229
  v_lshlrev_b32 v229, 1, v229
  v_add_u32 v229, s48, v229
  global_load_ushort v240, v229, s[14:15]
  v_add_u32 v229, 32, v228
  v_min_u32 v229, 111, v229
  v_lshlrev_b32 v229, 1, v229
  v_add_u32 v229, s48, v229
  global_load_ushort v241, v229, s[14:15]
  v_add_u32 v229, 64, v228
  v_min_u32 v229, 111, v229
  v_lshlrev_b32 v229, 1, v229
  v_add_u32 v229, s48, v229
  global_load_ushort v242, v229, s[14:15]
  v_add_u32 v229, 96, v228
  v_min_u32 v229, 111, v229
  v_lshlrev_b32 v229, 1, v229
  v_add_u32 v229, s48, v229
  global_load_ushort v243, v229, s[14:15]
  s_lshl_b32 s48, s47, 5
  s_add_u32 s48, s48, s41
  s_lshl_b32 s49, s40, 3
  s_add_u32 s56, s48, s49
  s_lshl_b32 s48, s56, 15
  v_lshl_add_u32 v248, v1, 4, s48
  s_mul_i32 s48, s56, 114688
  s_mul_i32 s49, s44, 7168
  s_add_u32 s48, s48, s49
  v_lshl_add_u32 v249, v1, 4, s48
  s_lshl_b32 s48, s56, 11
  v_bfe_u32 v228, v1, 4, 1
  v_lshlrev_b32 v228, 7, v228
  v_lshrrev_b32 v229, 5, v1
  v_lshl_add_u32 v228, v229, 6, v228
  v_lshl_add_u32 v228, v2, 2, v228
  v_add_u32 v250, s48, v228
  s_getpc_b64 s[50:51]
L_PF2:
  v_lshlrev_b32 v136, 7, v0
  v_add_u32 v136, L_P4CODE-L_PF2, v136
  v_min_u32 v136, L_END-L_PF2, v136
  global_load_dword v137, v136, s[50:51]
  s_waitcnt lgkmcnt(0)
  s_barrier
L_P4CODE:
  v_mov_b32 v255, v248
  s_mov_b32 s71, 0
  s_nop 0
L_P4TRY:
  v_mov_b32 v248, v255
  global_load_dword v188, v250, s[30:31] offset:0 sc1
  global_load_dword v189, v250, s[30:31] offset:256 sc1
  global_load_dword v190, v250, s[30:31] offset:512 sc1
  global_load_dword v191, v250, s[30:31] offset:768 sc1
  global_load_dword v192, v250, s[30:31] offset:1024 sc1
  global_load_dword v193, v250, s[30:31] offset:1280 sc1
  global_load_dword v194, v250, s[30:31] offset:1536 sc1
  global_load_dword v195, v250, s[30:31] offset:1792 sc1
  global_load_dwordx4 v[8:11], v248, s[28:29] offset:0 sc1
  global_load_dwordx4 v[12:15], v248, s[28:29] offset:1024 sc1
  global_load_dwordx4 v[16:19], v248, s[28:29] offset:2048 sc1
  global_load_dwordx4 v[20:23], v248, s[28:29] offset:3072 sc1
  v_add_u32 v248, 4096, v248
  global_load_dwordx4 v[24:27], v248, s[28:29] offset:0 sc1
  global_load_dwordx4 v[28:31], v248, s[28:29] offset:1024 sc1
  global_load_dwordx4 v[32:35], v248, s[28:29] offset:2048 sc1
  global_load_dwordx4 v[36:39], v248, s[28:29] offset:3072 sc1
  s_waitcnt vmcnt(13)
  v_max3_u32 v254, v188, v189, v190
  s_waitcnt vmcnt(11)
  v_max3_u32 v254, v254, v191, v192
  s_waitcnt vmcnt(9)
  v_max3_u32 v254, v254, v193, v194
  s_waitcnt vmcnt(8)
  v_max_u32 v254, v254, v195
  v_cmp_eq_u32 vcc, -1, v254
  s_nop 4
  s_cbranch_vccz L_P4GO
  s_waitcnt vmcnt(0)
  s_add_u32 s71, s71, 1
  s_cmp_gt_u32 s71, 0x100000
  s_cbranch_scc0 L_P4TRY
  v_mov_b32 v248, v255
  global_load_dwordx4 v[8:11], v248, s[28:29] offset:0 sc1
  global_load_dwordx4 v[12:15], v248, s[28:29] offset:1024 sc1
  global_load_dwordx4 v[16:19], v248, s[28:29] offset:2048 sc1
  global_load_dwordx4 v[20:23], v248, s[28:29] offset:3072 sc1
  v_add_u32 v248, 4096, v248
  global_load_dwordx4 v[24:27], v248, s[28:29] offset:0 sc1
  global_load_dwordx4 v[28:31], v248, s[28:29] offset:1024 sc1
  global_load_dwordx4 v[32:35], v248, s[28:29] offset:2048 sc1
  global_load_dwordx4 v[36:39], v248, s[28:29] offset:3072 sc1
  s_waitcnt vmcnt(0)
L_P4GO:
  v_mov_b32 v254, 0
  ds_read_b64_tr_b16 v[204:205], v4 offset:0
  ds_read_b64_tr_b16 v[206:207], v4 offset:28672
  ds_read_b64_tr_b16 v[208:209], v4 offset:256
  ds_read_b64_tr_b16 v[210:211], v4 offset:28928
  ds_read_b64_tr_b16 v[212:213], v4 offset:1792
  ds_read_b64_tr_b16 v[214:215], v4 offset:30464
  ds_read_b64_tr_b16 v[216:217], v4 offset:2048
  ds_read_b64_tr_b16 v[218:219], v4 offset:30720
  ds_read_b64_tr_b16 v[220:221], v5 offset:0
  ds_read_b64_tr_b16 v[222:223], v5 offset:28672
  s_waitcnt lgkmcnt(6)
  s_waitcnt vmcnt(7)
  v_mfma_f32_32x32x16_bf16 v[140:155], v[204:207], v[8:11], 0
  ds_read_b64_tr_b16 v[224:225], v5 offset:256
  ds_read_b64_tr_b16 v[226:227], v5 offset:28928
  v_add_u32 v248, 4096, v248
  global_load_dwordx4 v[40:43], v248, s[28:29] offset:0 sc1
  v_mfma_f32_32x32x16_bf16 v[156:171], v[208:211], v[8:11], 0
  ds_read_b64_tr_b16 v[204:205], v5 offset:1792
  ds_read_b64_tr_b16 v[206:207], v5 offset:30464
  v_max3_u32 v254, v254, v8, v11
  s_waitcnt lgkmcnt(6)
  s_waitcnt vmcnt(7)
  v_mfma_f32_32x32x16_bf16 v[140:155], v[212:215], v[12:15], v[140:155]
  ds_read_b64_tr_b16 v[208:209], v5 offset:2048
  ds_read_b64_tr_b16 v[210:211], v5 offset:30720
  global_load_dwordx4 v[44:47], v248, s[28:29] offset:1024 sc1
  v_mfma_f32_32x32x16_bf16 v[156:171], v[216:219], v[12:15], v[156:171]
  ds_read_b64_tr_b16 v[212:213], v4 offset:3584
  ds_read_b64_tr_b16 v[214:215], v4 offset:32256
  v_max3_u32 v254, v254, v12, v15
  s_waitcnt lgkmcnt(6)
  s_waitcnt vmcnt(7)
  v_mfma_f32_32x32x16_bf16 v[140:155], v[220:223], v[16:19], v[140:155]
  ds_read_b64_tr_b16 v[216:217], v4 offset:3840
  ds_read_b64_tr_b16 v[218:219], v4 offset:32512
  global_load_dwordx4 v[48:51], v248, s[28:29] offset:2048 sc1
  v_mfma_f32_32x32x16_bf16 v[156:171], v[224:227], v[16:19], v[156:171]
  ds_read_b64_tr_b16 v[220:221], v4 offset:5376
  ds_read_b64_tr_b16 v[222:223], v4 offset:34048
  v_max3_u32 v254, v254, v16, v19
  s_waitcnt lgkmcnt(6)
  s_waitcnt vmcnt(7)
  v_mfma_f32_32x32x16_bf16 v[140:155], v[204:207], v[20:23], v[140:155]
  ds_read_b64_tr_b16 v[224:225], v4 offset:5632
  ds_read_b64_tr_b16 v[226:227], v4 offset:34304
  global_load_dwordx4 v[52:55], v248, s[28:29] offset:3072 sc1
  v_add_u32 v249, 3072, v249
  v_and_b32 v228, 31, v1
  v_lshlrev_b32 v228, 2, v228
  v_mfma_f32_32x32x16_bf16 v[156:171], v[208:211], v[20:23], v[156:171]
  ds_read_b64_tr_b16 v[204:205], v5 offset:3584
  ds_read_b64_tr_b16 v[206:207], v5 offset:32256
  v_max3_u32 v254, v254, v20, v23
  v_add_u32 v228, 162816, v228
  s_waitcnt lgkmcnt(6)
  s_waitcnt vmcnt(7)
  v_mfma_f32_32x32x16_bf16 v[140:155], v[212:215], v[24:27], v[140:155]
  ds_read_b64_tr_b16 v[208:209], v5 offset:3840
  ds_read_b64_tr_b16 v[210:211], v5 offset:32512
  v_add_u32 v248, 4096, v248
  global_load_dwordx4 v[56:59], v248, s[28:29] offset:0 sc1
  ds_read_b32 v232, v228 offset:0
  v_mfma_f32_32x32x16_bf16 v[156:171], v[216:219], v[24:27], v[156:171]
  ds_read_b64_tr_b16 v[212:213], v5 offset:5376
  ds_read_b64_tr_b16 v[214:215], v5 offset:34048
  v_max3_u32 v254, v254, v24, v27
  ds_read_b32 v233, v228 offset:128
  ds_read_b32 v234, v228 offset:256
  ds_read_b32 v235, v228 offset:384
  v_mov_b32 v229, 0
  v_cmp_gt_u32 vcc, 32, v1
  s_waitcnt lgkmcnt(5)
  v_cvt_pk_bf16_f32 v236, v232, v232
  s_waitcnt lgkmcnt(6)
  s_waitcnt vmcnt(7)
  v_mfma_f32_32x32x16_bf16 v[140:155], v[220:223], v[28:31], v[140:155]
  ds_read_b64_tr_b16 v[216:217], v5 offset:5632
  ds_read_b64_tr_b16 v[218:219], v5 offset:34304
  global_load_dwordx4 v[60:63], v248, s[28:29] offset:1024 sc1
  v_and_b32 v237, 0xffff0000, v236
  v_sub_f32 v232, v232, v237
  v_cvt_pk_bf16_f32 v237, v232, v232
  v_mfma_f32_32x32x16_bf16 v[156:171], v[224:227], v[28:31], v[156:171]
  ds_read_b64_tr_b16 v[220:221], v4 offset:7168
  ds_read_b64_tr_b16 v[222:223], v4 offset:35840
  v_max3_u32 v254, v254, v28, v31
  v_and_b32 v236, 0xffff, v236
  v_and_b32 v237, 0xffff0000, v237
  s_waitcnt lgkmcnt(6)
  s_waitcnt vmcnt(7)
  v_mfma_f32_32x32x16_bf16 v[140:155], v[204:207], v[32:35], v[140:155]
  ds_read_b64_tr_b16 v[224:225], v4 offset:7424
  ds_read_b64_tr_b16 v[226:227], v4 offset:36096
  global_load_dwordx4 v[64:67], v248, s[28:29] offset:2048 sc1
  v_or_b32 v236, v236, v237
  v_cndmask_b32 v236, v229, v236, vcc
  v_cndmask_b32 v237, v229, v240, vcc
  v_mfma_f32_32x32x16_bf16 v[156:171], v[208:211], v[32:35], v[156:171]
  ds_read_b64_tr_b16 v[204:205], v4 offset:8960
  ds_read_b64_tr_b16 v[206:207], v4 offset:37632
  v_max3_u32 v254, v254, v32, v35
  v_accvgpr_write_b32 a224, v236
  v_accvgpr_write_b32 a225, v237
  v_accvgpr_write_b32 a226, v229
  s_waitcnt lgkmcnt(6)
  s_waitcnt vmcnt(7)
  v_mfma_f32_32x32x16_bf16 v[140:155], v[212:215], v[36:39], v[140:155]
  ds_read_b64_tr_b16 v[208:209], v4 offset:9216
  ds_read_b64_tr_b16 v[210:211], v4 offset:37888
  global_load_dwordx4 v[68:71], v248, s[28:29] offset:3072 sc1
  v_accvgpr_write_b32 a227, v229
  v_cvt_pk_bf16_f32 v236, v233, v233
  v_and_b32 v237, 0xffff0000, v236
  v_mfma_f32_32x32x16_bf16 v[156:171], v[216:219], v[36:39], v[156:171]
  ds_read_b64_tr_b16 v[212:213], v5 offset:7168
  ds_read_b64_tr_b16 v[214:215], v5 offset:35840
  v_max3_u32 v254, v254, v36, v39
  v_sub_f32 v233, v233, v237
  v_cvt_pk_bf16_f32 v237, v233, v233
  s_waitcnt lgkmcnt(6)
  s_waitcnt vmcnt(7)
  v_mfma_f32_32x32x16_bf16 v[140:155], v[220:223], v[40:43], v[140:155]
  ds_read_b64_tr_b16 v[216:217], v5 offset:7424
  ds_read_b64_tr_b16 v[218:219], v5 offset:36096
  v_add_u32 v248, 4096, v248
  global_load_dwordx4 v[72:75], v248, s[28:29] offset:0 sc1
  v_and_b32 v236, 0xffff, v236
  v_and_b32 v237, 0xffff0000, v237
  v_or_b32 v236, v236, v237
  v_mfma_f32_32x32x16_bf16 v[156:171], v[224:227], v[40:43], v[156:171]
  ds_read_b64_tr_b16 v[220:221], v5 offset:8960
  ds_read_b64_tr_b16 v[222:223], v5 offset:37632
  v_max3_u32 v254, v254, v40, v43
  v_cndmask_b32 v236, v229, v236, vcc
  v_cndmask_b32 v237, v229, v241, vcc
  v_accvgpr_write_b32 a228, v236
  s_waitcnt lgkmcnt(6)
  s_waitcnt vmcnt(7)
  v_mfma_f32_32x32x16_bf16 v[140:155], v[204:207], v[44:47], v[140:155]
  ds_read_b64_tr_b16 v[224:225], v5 offset:9216
  ds_read_b64_tr_b16 v[226:227], v5 offset:37888
  global_load_dwordx4 v[76:79], v248, s[28:29] offset:1024 sc1
  v_accvgpr_write_b32 a229, v237
  v_accvgpr_write_b32 a230, v229
  v_accvgpr_write_b32 a231, v229
  v_mfma_f32_32x32x16_bf16 v[156:171], v[208:211], v[44:47], v[156:171]
  ds_read_b64_tr_b16 v[204:205], v4 offset:10752
  ds_read_b64_tr_b16 v[206:207], v4 offset:39424
  v_max3_u32 v254, v254, v44, v47
  v_cvt_pk_bf16_f32 v236, v234, v234
  v_and_b32 v237, 0xffff0000, v236
  s_waitcnt lgkmcnt(6)
  s_waitcnt vmcnt(7)
  v_mfma_f32_32x32x16_bf16 v[140:155], v[212:215], v[48:51], v[140:155]
  ds_read_b64_tr_b16 v[208:209], v4 offset:11008
  ds_read_b64_tr_b16 v[210:211], v4 offset:39680
  global_load_dwordx4 v[80:83], v248, s[28:29] offset:2048 sc1
  v_sub_f32 v234, v234, v237
  v_cvt_pk_bf16_f32 v237, v234, v234
  v_and_b32 v236, 0xffff, v236
  v_mfma_f32_32x32x16_bf16 v[156:171], v[216:219], v[48:51], v[156:171]
  ds_read_b64_tr_b16 v[212:213], v4 offset:12544
  ds_read_b64_tr_b16 v[214:215], v4 offset:41216
  v_max3_u32 v254, v254, v48, v51
  v_and_b32 v237, 0xffff0000, v237
  v_or_b32 v236, v236, v237
  v_cndmask_b32 v236, v229, v236, vcc
  s_waitcnt lgkmcnt(6)
  s_waitcnt vmcnt(7)
  v_mfma_f32_32x32x16_bf16 v[140:155], v[220:223], v[52:55], v[140:155]
  ds_read_b64_tr_b16 v[216:217], v4 offset:12800
  ds_read_b64_tr_b16 v[218:219], v4 offset:41472
  global_load_dwordx4 v[84:87], v248, s[28:29] offset:3072 sc1
  v_cndmask_b32 v237, v229, v242, vcc
  v_accvgpr_write_b32 a232, v236
  v_accvgpr_write_b32 a233, v237
  v_mfma_f32_32x32x16_bf16 v[156:171], v[224:227], v[52:55], v[156:171]
  ds_read_b64_tr_b16 v[220:221], v5 offset:10752
  ds_read_b64_tr_b16 v[222:223], v5 offset:39424
  v_max3_u32 v254, v254, v52, v55
  v_accvgpr_write_b32 a234, v229
  v_accvgpr_write_b32 a235, v229
  s_waitcnt lgkmcnt(6)
  s_waitcnt vmcnt(7)
  v_mfma_f32_32x32x16_bf16 v[140:155], v[204:207], v[56:59], v[140:155]
  ds_read_b64_tr_b16 v[224:225], v5 offset:11008
  ds_read_b64_tr_b16 v[226:227], v5 offset:39680
  v_add_u32 v248, 4096, v248
  global_load_dwordx4 v[88:91], v248, s[28:29] offset:0 sc1
  v_cvt_pk_bf16_f32 v236, v235, v235
  v_and_b32 v237, 0xffff0000, v236
  v_sub_f32 v235, v235, v237
  v_mfma_f32_32x32x16_bf16 v[156:171], v[208:211], v[56:59], v[156:171]
  ds_read_b64_tr_b16 v[204:205], v5 offset:12544
  ds_read_b64_tr_b16 v[206:207], v5 offset:41216
  v_max3_u32 v254, v254, v56, v59
  v_cvt_pk_bf16_f32 v237, v235, v235
  v_and_b32 v236, 0xffff, v236
  v_and_b32 v237, 0xffff0000, v237
  s_waitcnt lgkmcnt(6)
  s_waitcnt vmcnt(7)
  v_mfma_f32_32x32x16_bf16 v[140:155], v[212:215], v[60:63], v[140:155]
  ds_read_b64_tr_b16 v[208:209], v5 offset:12800
  ds_read_b64_tr_b16 v[210:211], v5 offset:41472
  global_load_dwordx4 v[92:95], v248, s[28:29] offset:1024 sc1
  v_or_b32 v236, v236, v237
  v_cndmask_b32 v236, v229, v236, vcc
  v_mfma_f32_32x32x16_bf16 v[156:171], v[216:219], v[60:63], v[156:171]
  ds_read_b64_tr_b16 v[212:213], v4 offset:14336
  ds_read_b64_tr_b16 v[214:215], v4 offset:43008
  v_max3_u32 v254, v254, v60, v63
  v_cndmask_b32 v237, v229, v243, vcc
  v_accvgpr_write_b32 a236, v236
  v_accvgpr_write_b32 a237, v237
  s_waitcnt lgkmcnt(6)
  s_waitcnt vmcnt(7)
  v_mfma_f32_32x32x16_bf16 v[140:155], v[220:223], v[64:67], v[140:155]
  ds_read_b64_tr_b16 v[216:217], v4 offset:14592
  ds_read_b64_tr_b16 v[218:219], v4 offset:43264
  global_load_dwordx4 v[96:99], v248, s[28:29] offset:2048 sc1
  v_accvgpr_write_b32 a238, v229
  v_accvgpr_write_b32 a239, v229
  v_add_f32 v188, v188, v189
  v_mfma_f32_32x32x16_bf16 v[156:171], v[224:227], v[64:67], v[156:171]
  ds_read_b64_tr_b16 v[220:221], v4 offset:16128
  ds_read_b64_tr_b16 v[222:223], v4 offset:44800
  v_max3_u32 v254, v254, v64, v67
  v_add_f32 v188, v188, v190
  v_add_f32 v188, v188, v191
  v_add_f32 v188, v188, v192
  s_waitcnt lgkmcnt(6)
  s_waitcnt vmcnt(7)
  v_mfma_f32_32x32x16_bf16 v[140:155], v[204:207], v[68:71], v[140:155]
  ds_read_b64_tr_b16 v[224:225], v4 offset:16384
  ds_read_b64_tr_b16 v[226:227], v4 offset:45056
  global_load_dwordx4 v[100:103], v248, s[28:29] offset:3072 sc1
  v_add_f32 v188, v188, v193
  v_add_f32 v188, v188, v194
  v_mfma_f32_32x32x16_bf16 v[156:171], v[208:211], v[68:71], v[156:171]
  ds_read_b64_tr_b16 v[204:205], v5 offset:14336
  ds_read_b64_tr_b16 v[206:207], v5 offset:43008
  v_max3_u32 v254, v254, v68, v71
  v_add_f32 v188, v188, v195
  v_mov_b32 v189, v188
  s_nop 1
  v_permlane32_swap_b32 v188, v189
  s_waitcnt lgkmcnt(6)
  s_waitcnt vmcnt(7)
  v_mfma_f32_32x32x16_bf16 v[140:155], v[212:215], v[72:75], v[140:155]
  ds_read_b64_tr_b16 v[208:209], v5 offset:14592
  ds_read_b64_tr_b16 v[210:211], v5 offset:43264
  v_add_u32 v248, 4096, v248
  global_load_dwordx4 v[104:107], v248, s[28:29] offset:0 sc1
  v_mul_f32 v190, 0x3b000000, v188
  v_mul_f32 v192, 0x3b000000, v189
  v_fma_f32 v192, -v190, v190, v192
  v_mfma_f32_32x32x16_bf16 v[156:171], v[216:219], v[72:75], v[156:171]
  ds_read_b64_tr_b16 v[212:213], v5 offset:16128
  ds_read_b64_tr_b16 v[214:215], v5 offset:44800
  v_max3_u32 v254, v254, v72, v75
  v_max_f32 v192, 0, v192
  v_cvt_pk_bf16_f32 v193, v192, v192
  v_lshlrev_b32 v192, 16, v193
  s_waitcnt lgkmcnt(6)
  s_waitcnt vmcnt(7)
  v_mfma_f32_32x32x16_bf16 v[140:155], v[220:223], v[76:79], v[140:155]
  ds_read_b64_tr_b16 v[216:217], v5 offset:16384
  ds_read_b64_tr_b16 v[218:219], v5 offset:45056
  global_load_dwordx4 v[108:111], v248, s[28:29] offset:1024 sc1
  v_add_f32 v192, 0x3727c5ac, v192
  v_cvt_pk_bf16_f32 v193, v192, v192
  v_mfma_f32_32x32x16_bf16 v[156:171], v[224:227], v[76:79], v[156:171]
  ds_read_b64_tr_b16 v[220:221], v4 offset:17920
  ds_read_b64_tr_b16 v[222:223], v4 offset:46592
  v_max3_u32 v254, v254, v76, v79
  v_lshlrev_b32 v192, 16, v193
  v_sqrt_f32 v192, v192
  s_waitcnt lgkmcnt(6)
  s_waitcnt vmcnt(7)
  v_mfma_f32_32x32x16_bf16 v[140:155], v[204:207], v[80:83], v[140:155]
  ds_read_b64_tr_b16 v[224:225], v4 offset:18176
  ds_read_b64_tr_b16 v[226:227], v4 offset:46848
  global_load_dwordx4 v[112:115], v248, s[28:29] offset:2048 sc1
  v_cvt_pk_bf16_f32 v193, v192, v192
  v_lshlrev_b32 v191, 16, v193
  v_mfma_f32_32x32x16_bf16 v[156:171], v[208:211], v[80:83], v[156:171]
  ds_read_b64_tr_b16 v[204:205], v4 offset:19712
  ds_read_b64_tr_b16 v[206:207], v4 offset:48384
  v_max3_u32 v254, v254, v80, v83
  v_rcp_f32 v192, v191
  s_nop 0
  v_mul_f32 v251, 0x3fb8aa3b, v192
  v_sub_f32 v190, 0, v190
  s_waitcnt lgkmcnt(6)
  s_waitcnt vmcnt(7)
  v_mfma_f32_32x32x16_bf16 v[140:155], v[212:215], v[84:87], v[140:155]
  ds_read_b64_tr_b16 v[208:209], v4 offset:19968
  ds_read_b64_tr_b16 v[210:211], v4 offset:48640
  global_load_dwordx4 v[116:119], v248, s[28:29] offset:3072 sc1
  v_cvt_pk_bf16_f32 v136, v190, v190
  v_lshrrev_b32 v137, 16, v191
  v_mfma_f32_32x32x16_bf16 v[156:171], v[216:219], v[84:87], v[156:171]
  ds_read_b64_tr_b16 v[212:213], v5 offset:17920
  ds_read_b64_tr_b16 v[214:215], v5 offset:46592
  v_max3_u32 v254, v254, v84, v87
  v_mov_b32 v138, 0
  v_mov_b32 v139, 0
  v_mov_b32 v252, 0xbfb17218
  s_waitcnt lgkmcnt(6)
  s_waitcnt vmcnt(7)
  v_mfma_f32_32x32x16_bf16 v[140:155], v[220:223], v[88:91], v[140:155]
  ds_read_b64_tr_b16 v[216:217], v5 offset:18176
  ds_read_b64_tr_b16 v[218:219], v5 offset:46848
  v_add_u32 v248, 4096, v248
  global_load_dwordx4 v[120:123], v248, s[28:29] offset:0 sc1
  v_mfma_f32_32x32x16_bf16 v[156:171], v[224:227], v[88:91], v[156:171]
  ds_read_b64_tr_b16 v[220:221], v5 offset:19712
  ds_read_b64_tr_b16 v[222:223], v5 offset:48384
  v_max3_u32 v254, v254, v88, v91
  s_waitcnt lgkmcnt(6)
  s_waitcnt vmcnt(7)
  v_mfma_f32_32x32x16_bf16 v[140:155], v[204:207], v[92:95], v[140:155]
  ds_read_b64_tr_b16 v[224:225], v5 offset:19968
  ds_read_b64_tr_b16 v[226:227], v5 offset:48640
  global_load_dwordx4 v[124:127], v248, s[28:29] offset:1024 sc1
  v_mfma_f32_32x32x16_bf16 v[156:171], v[208:211], v[92:95], v[156:171]
  ds_read_b64_tr_b16 v[204:205], v4 offset:21504
  ds_read_b64_tr_b16 v[206:207], v4 offset:50176
  v_max3_u32 v254, v254, v92, v95
  s_waitcnt lgkmcnt(6)
  s_waitcnt vmcnt(7)
  v_mfma_f32_32x32x16_bf16 v[140:155], v[212:215], v[96:99], v[140:155]
  ds_read_b64_tr_b16 v[208:209], v4 offset:21760
  ds_read_b64_tr_b16 v[210:211], v4 offset:50432
  global_load_dwordx4 v[128:131], v248, s[28:29] offset:2048 sc1
  v_mfma_f32_32x32x16_bf16 v[156:171], v[216:219], v[96:99], v[156:171]
  ds_read_b64_tr_b16 v[212:213], v4 offset:23296
  ds_read_b64_tr_b16 v[214:215], v4 offset:51968
  v_max3_u32 v254, v254, v96, v99
  s_waitcnt lgkmcnt(6)
  s_waitcnt vmcnt(7)
  v_mfma_f32_32x32x16_bf16 v[140:155], v[220:223], v[100:103], v[140:155]
  ds_read_b64_tr_b16 v[216:217], v4 offset:23552
  ds_read_b64_tr_b16 v[218:219], v4 offset:52224
  global_load_dwordx4 v[132:135], v248, s[28:29] offset:3072 sc1
  v_mfma_f32_32x32x16_bf16 v[156:171], v[224:227], v[100:103], v[156:171]
  ds_read_b64_tr_b16 v[220:221], v5 offset:21504
  ds_read_b64_tr_b16 v[222:223], v5 offset:50176
  v_max3_u32 v254, v254, v100, v103
  s_waitcnt lgkmcnt(6)
  s_waitcnt vmcnt(7)
  v_mfma_f32_32x32x16_bf16 v[140:155], v[204:207], v[104:107], v[140:155]
  ds_read_b64_tr_b16 v[224:225], v5 offset:21760
  ds_read_b64_tr_b16 v[226:227], v5 offset:50432
  v_mfma_f32_32x32x16_bf16 v[156:171], v[208:211], v[104:107], v[156:171]
  ds_read_b64_tr_b16 v[204:205], v5 offset:23296
  ds_read_b64_tr_b16 v[206:207], v5 offset:51968
  v_max3_u32 v254, v254, v104, v107
  s_waitcnt lgkmcnt(6)
  s_waitcnt vmcnt(6)
  v_mfma_f32_32x32x16_bf16 v[140:155], v[212:215], v[108:111], v[140:155]
  ds_read_b64_tr_b16 v[208:209], v5 offset:23552
  ds_read_b64_tr_b16 v[210:211], v5 offset:52224
  v_mfma_f32_32x32x16_bf16 v[156:171], v[216:219], v[108:111], v[156:171]
  ds_read_b64_tr_b16 v[212:213], v4 offset:25088
  ds_read_b64_tr_b16 v[214:215], v4 offset:53760
  v_max3_u32 v254, v254, v108, v111
  s_waitcnt lgkmcnt(6)
  s_waitcnt vmcnt(5)
  v_mfma_f32_32x32x16_bf16 v[140:155], v[220:223], v[112:115], v[140:155]
  ds_read_b64_tr_b16 v[216:217], v4 offset:25344
  ds_read_b64_tr_b16 v[218:219], v4 offset:54016
  v_mfma_f32_32x32x16_bf16 v[156:171], v[224:227], v[112:115], v[156:171]
  ds_read_b64_tr_b16 v[220:221], v4 offset:26880
  ds_read_b64_tr_b16 v[222:223], v4 offset:55552
  v_max3_u32 v254, v254, v112, v115
  s_waitcnt lgkmcnt(6)
  s_waitcnt vmcnt(4)
  v_mfma_f32_32x32x16_bf16 v[140:155], v[204:207], v[116:119], v[140:155]
  ds_read_b64_tr_b16 v[224:225], v4 offset:27136
  ds_read_b64_tr_b16 v[226:227], v4 offset:55808
  v_mfma_f32_32x32x16_bf16 v[156:171], v[208:211], v[116:119], v[156:171]
  ds_read_b64_tr_b16 v[204:205], v5 offset:25088
  ds_read_b64_tr_b16 v[206:207], v5 offset:53760
  v_max3_u32 v254, v254, v116, v119
  s_waitcnt lgkmcnt(6)
  s_waitcnt vmcnt(3)
  v_mfma_f32_32x32x16_bf16 v[140:155], v[212:215], v[120:123], v[140:155]
  ds_read_b64_tr_b16 v[208:209], v5 offset:25344
  ds_read_b64_tr_b16 v[210:211], v5 offset:54016
  v_mfma_f32_32x32x16_bf16 v[156:171], v[216:219], v[120:123], v[156:171]
  ds_read_b64_tr_b16 v[212:213], v5 offset:26880
  ds_read_b64_tr_b16 v[214:215], v5 offset:55552
  v_max3_u32 v254, v254, v120, v123
  s_waitcnt lgkmcnt(6)
  s_waitcnt vmcnt(2)
  v_mfma_f32_32x32x16_bf16 v[140:155], v[220:223], v[124:127], v[140:155]
  ds_read_b64_tr_b16 v[216:217], v5 offset:27136
  ds_read_b64_tr_b16 v[218:219], v5 offset:55808
  v_mfma_f32_32x32x16_bf16 v[156:171], v[224:227], v[124:127], v[156:171]
  v_max3_u32 v254, v254, v124, v127
  s_waitcnt vmcnt(1) lgkmcnt(6)
  v_mfma_f32_32x32x16_bf16 v[140:155], v[204:207], v[128:131], v[140:155]
  s_waitcnt lgkmcnt(4)
  v_mfma_f32_32x32x16_bf16 v[156:171], v[208:211], v[128:131], v[156:171]
  v_max3_u32 v254, v254, v128, v131
  s_waitcnt vmcnt(0) lgkmcnt(2)
  v_mfma_f32_32x32x16_bf16 v[140:155], v[212:215], v[132:135], v[140:155]
  s_waitcnt lgkmcnt(0)
  v_mfma_f32_32x32x16_bf16 v[156:171], v[216:219], v[132:135], v[156:171]
  v_max3_u32 v254, v254, v132, v135
  v_cmp_eq_u32 vcc, -1, v254
  s_nop 4
  s_cbranch_vccnz L_P4REDO
  s_nop 3
L_P4AOK:
  v_mfma_f32_32x32x16_bf16 v[140:155], a[224:227], v[136:139], v[140:155]
  v_mfma_f32_32x32x16_bf16 v[156:171], a[228:231], v[136:139], v[156:171]
  ds_read_b64_tr_b16 v[204:205], v4 offset:512
  ds_read_b64_tr_b16 v[206:207], v4 offset:29184
  ds_read_b64_tr_b16 v[208:209], v4 offset:2304
  ds_read_b64_tr_b16 v[210:211], v4 offset:30976
  ds_read_b64_tr_b16 v[212:213], v5 offset:512
  ds_read_b64_tr_b16 v[214:215], v5 offset:29184
  ds_read_b64_tr_b16 v[216:217], v5 offset:2304
  ds_read_b64_tr_b16 v[218:219], v5 offset:30976
  ds_read_b64_tr_b16 v[220:221], v4 offset:4096
  ds_read_b64_tr_b16 v[222:223], v4 offset:32768
  s_waitcnt lgkmcnt(6)
  v_mfma_f32_32x32x16_bf16 v[172:187], v[204:207], v[8:11], 0
  ds_read_b64_tr_b16 v[224:225], v4 offset:5888
  ds_read_b64_tr_b16 v[226:227], v4 offset:34560
  v_mul_f32 v228, v140, v251
  v_mul_f32 v229, v141, v251
  v_mul_f32 v230, v142, v251
  v_mul_f32 v231, v143, v251
  v_mul_f32 v232, v144, v251
  v_mfma_f32_32x32x16_bf16 v[172:187], v[208:211], v[12:15], v[172:187]
  ds_read_b64_tr_b16 v[204:205], v5 offset:4096
  ds_read_b64_tr_b16 v[206:207], v5 offset:32768
  v_lshl_add_u32 v253, v1, 4, s3
  global_load_dwordx4 a[112:115], v253, s[68:69] offset:0 sc1
  v_mul_f32 v233, v145, v251
  v_mul_f32 v234, v146, v251
  v_mul_f32 v235, v147, v251
  v_exp_f32 v236, v228
  s_waitcnt lgkmcnt(6)
  v_mfma_f32_32x32x16_bf16 v[172:187], v[212:215], v[16:19], v[172:187]
  ds_read_b64_tr_b16 v[208:209], v5 offset:5888
  ds_read_b64_tr_b16 v[210:211], v5 offset:34560
  v_exp_f32 v237, v229
  v_exp_f32 v238, v230
  v_mfma_f32_32x32x16_bf16 v[172:187], v[216:219], v[20:23], v[172:187]
  ds_read_b64_tr_b16 v[212:213], v4 offset:7680
  ds_read_b64_tr_b16 v[214:215], v4 offset:36352
  global_load_dwordx4 a[116:119], v253, s[68:69] offset:1024 sc1
  v_exp_f32 v239, v231
  v_exp_f32 v240, v232
  s_waitcnt lgkmcnt(6)
  v_mfma_f32_32x32x16_bf16 v[172:187], v[220:223], v[24:27], v[172:187]
  ds_read_b64_tr_b16 v[216:217], v4 offset:9472
  ds_read_b64_tr_b16 v[218:219], v4 offset:38144
  v_exp_f32 v241, v233
  v_exp_f32 v242, v234
  v_exp_f32 v243, v235
  v_mfma_f32_32x32x16_bf16 v[172:187], v[224:227], v[28:31], v[172:187]
  ds_read_b64_tr_b16 v[220:221], v5 offset:7680
  ds_read_b64_tr_b16 v[222:223], v5 offset:36352
  global_load_dwordx4 a[120:123], v253, s[68:69] offset:2048 sc1
  v_add_f32 v236, 1.0, v236
  v_add_f32 v237, 1.0, v237
  v_add_f32 v238, 1.0, v238
  v_add_f32 v239, 1.0, v239
  s_waitcnt lgkmcnt(6)
  v_mfma_f32_32x32x16_bf16 v[172:187], v[204:207], v[32:35], v[172:187]
  ds_read_b64_tr_b16 v[224:225], v5 offset:9472
  ds_read_b64_tr_b16 v[226:227], v5 offset:38144
  v_add_f32 v240, 1.0, v240
  v_add_f32 v241, 1.0, v241
  v_add_f32 v242, 1.0, v242
  v_add_f32 v243, 1.0, v243
  v_fma_f32 v236, v236, v236, 1.0
  v_mfma_f32_32x32x16_bf16 v[172:187], v[208:211], v[36:39], v[172:187]
  ds_read_b64_tr_b16 v[204:205], v4 offset:11264
  ds_read_b64_tr_b16 v[206:207], v4 offset:39936
  global_load_dwordx4 a[124:127], v253, s[68:69] offset:3072 sc1
  v_fma_f32 v237, v237, v237, 1.0
  v_fma_f32 v238, v238, v238, 1.0
  v_fma_f32 v239, v239, v239, 1.0
  v_fma_f32 v240, v240, v240, 1.0
  s_waitcnt lgkmcnt(6)
  v_mfma_f32_32x32x16_bf16 v[172:187], v[212:215], v[40:43], v[172:187]
  ds_read_b64_tr_b16 v[208:209], v4 offset:13056
  ds_read_b64_tr_b16 v[210:211], v4 offset:41728
  v_fma_f32 v241, v241, v241, 1.0
  v_fma_f32 v242, v242, v242, 1.0
  v_fma_f32 v243, v243, v243, 1.0
  v_rcp_f32 v236, v236
  v_mfma_f32_32x32x16_bf16 v[172:187], v[216:219], v[44:47], v[172:187]
  ds_read_b64_tr_b16 v[212:213], v5 offset:11264
  ds_read_b64_tr_b16 v[214:215], v5 offset:39936
  v_add_u32 v253, 4096, v253
  global_load_dwordx4 a[128:131], v253, s[68:69] offset:0 sc1
  v_rcp_f32 v237, v237
  v_rcp_f32 v238, v238
  s_waitcnt lgkmcnt(6)
  v_mfma_f32_32x32x16_bf16 v[172:187], v[220:223], v[48:51], v[172:187]
  ds_read_b64_tr_b16 v[216:217], v5 offset:13056
  ds_read_b64_tr_b16 v[218:219], v5 offset:41728
  v_rcp_f32 v239, v239
  v_rcp_f32 v240, v240
  v_rcp_f32 v241, v241
  v_mfma_f32_32x32x16_bf16 v[172:187], v[224:227], v[52:55], v[172:187]
  ds_read_b64_tr_b16 v[220:221], v4 offset:14848
  ds_read_b64_tr_b16 v[222:223], v4 offset:43520
  global_load_dwordx4 a[132:135], v253, s[68:69] offset:1024 sc1
  v_rcp_f32 v242, v242
  v_rcp_f32 v243, v243
  s_waitcnt lgkmcnt(6)
  v_mfma_f32_32x32x16_bf16 v[172:187], v[204:207], v[56:59], v[172:187]
  ds_read_b64_tr_b16 v[224:225], v4 offset:16640
  ds_read_b64_tr_b16 v[226:227], v4 offset:45312
  v_fmaak_f32 v236, v236, v252, 0x3f317218
  v_fmaak_f32 v237, v237, v252, 0x3f317218
  v_fmaak_f32 v238, v238, v252, 0x3f317218
  v_fmaak_f32 v239, v239, v252, 0x3f317218
  v_fmaak_f32 v240, v240, v252, 0x3f317218
  v_mfma_f32_32x32x16_bf16 v[172:187], v[208:211], v[60:63], v[172:187]
  ds_read_b64_tr_b16 v[204:205], v5 offset:14848
  ds_read_b64_tr_b16 v[206:207], v5 offset:43520
  global_load_dwordx4 a[136:139], v253, s[68:69] offset:2048 sc1
  v_fmaak_f32 v241, v241, v252, 0x3f317218
  v_fmaak_f32 v242, v242, v252, 0x3f317218
  v_fmaak_f32 v243, v243, v252, 0x3f317218
  v_mul_f32 v228, v228, v236
  s_waitcnt lgkmcnt(6)
  v_mfma_f32_32x32x16_bf16 v[172:187], v[212:215], v[64:67], v[172:187]
  ds_read_b64_tr_b16 v[208:209], v5 offset:16640
  ds_read_b64_tr_b16 v[210:211], v5 offset:45312
  v_mul_f32 v229, v229, v237
  v_mul_f32 v230, v230, v238
  v_mul_f32 v231, v231, v239
  v_mul_f32 v232, v232, v240
  v_mul_f32 v233, v233, v241
  v_mfma_f32_32x32x16_bf16 v[172:187], v[216:219], v[68:71], v[172:187]
  ds_read_b64_tr_b16 v[212:213], v4 offset:18432
  ds_read_b64_tr_b16 v[214:215], v4 offset:47104
  global_load_dwordx4 a[140:143], v253, s[68:69] offset:3072 sc1
  v_mul_f32 v234, v234, v242
  v_mul_f32 v235, v235, v243
  v_cvt_pk_bf16_f32 v244, v228, v229
  v_cvt_pk_bf16_f32 v245, v230, v231
  v_cvt_pk_bf16_f32 v246, v232, v233
  s_waitcnt lgkmcnt(6)
  v_mfma_f32_32x32x16_bf16 v[172:187], v[220:223], v[72:75], v[172:187]
  ds_read_b64_tr_b16 v[216:217], v4 offset:20224
  ds_read_b64_tr_b16 v[218:219], v4 offset:48896
  v_cvt_pk_bf16_f32 v247, v234, v235
  v_mfma_f32_32x32x16_bf16 v[172:187], v[224:227], v[76:79], v[172:187]
  ds_read_b64_tr_b16 v[220:221], v5 offset:18432
  ds_read_b64_tr_b16 v[222:223], v5 offset:47104
  v_add_u32 v253, 4096, v253
  global_load_dwordx4 a[144:147], v253, s[68:69] offset:0 sc1
  global_store_dwordx4 v249, v[244:247], s[32:33] offset:-3072 sc1
  v_mul_f32 v228, v148, v251
  v_mul_f32 v229, v149, v251
  v_mul_f32 v230, v150, v251
  v_mul_f32 v231, v151, v251
  v_mul_f32 v232, v152, v251
  v_mul_f32 v233, v153, v251
  v_mul_f32 v234, v154, v251
  s_waitcnt lgkmcnt(6)
  v_mfma_f32_32x32x16_bf16 v[172:187], v[204:207], v[80:83], v[172:187]
  ds_read_b64_tr_b16 v[224:225], v5 offset:20224
  ds_read_b64_tr_b16 v[226:227], v5 offset:48896
  v_mul_f32 v235, v155, v251
  v_exp_f32 v236, v228
  v_exp_f32 v237, v229
  v_mfma_f32_32x32x16_bf16 v[172:187], v[208:211], v[84:87], v[172:187]
  ds_read_b64_tr_b16 v[204:205], v4 offset:22016
  ds_read_b64_tr_b16 v[206:207], v4 offset:50688
  global_load_dwordx4 a[148:151], v253, s[68:69] offset:1024 sc1
  v_exp_f32 v238, v230
  v_exp_f32 v239, v231
  s_waitcnt lgkmcnt(6)
  v_mfma_f32_32x32x16_bf16 v[172:187], v[212:215], v[88:91], v[172:187]
  ds_read_b64_tr_b16 v[208:209], v4 offset:23808
  ds_read_b64_tr_b16 v[210:211], v4 offset:52480
  v_exp_f32 v240, v232
  v_exp_f32 v241, v233
  v_exp_f32 v242, v234
  v_mfma_f32_32x32x16_bf16 v[172:187], v[216:219], v[92:95], v[172:187]
  ds_read_b64_tr_b16 v[212:213], v5 offset:22016
  ds_read_b64_tr_b16 v[214:215], v5 offset:50688
  global_load_dwordx4 a[152:155], v253, s[68:69] offset:2048 sc1
  v_exp_f32 v243, v235
  v_add_f32 v236, 1.0, v236
  v_add_f32 v237, 1.0, v237
  s_waitcnt lgkmcnt(6)
  v_mfma_f32_32x32x16_bf16 v[172:187], v[220:223], v[96:99], v[172:187]
  ds_read_b64_tr_b16 v[216:217], v5 offset:23808
  ds_read_b64_tr_b16 v[218:219], v5 offset:52480
  v_add_f32 v238, 1.0, v238
  v_add_f32 v239, 1.0, v239
  v_add_f32 v240, 1.0, v240
  v_add_f32 v241, 1.0, v241
  v_mfma_f32_32x32x16_bf16 v[172:187], v[224:227], v[100:103], v[172:187]
  ds_read_b64_tr_b16 v[220:221], v4 offset:25600
  ds_read_b64_tr_b16 v[222:223], v4 offset:54272
  global_load_dwordx4 a[156:159], v253, s[68:69] offset:3072 sc1
  v_add_f32 v242, 1.0, v242
  v_add_f32 v243, 1.0, v243
  v_fma_f32 v236, v236, v236, 1.0
  v_fma_f32 v237, v237, v237, 1.0
  v_fma_f32 v238, v238, v238, 1.0
  s_waitcnt lgkmcnt(6)
  v_mfma_f32_32x32x16_bf16 v[172:187], v[204:207], v[104:107], v[172:187]
  ds_read_b64_tr_b16 v[224:225], v4 offset:27392
  ds_read_b64_tr_b16 v[226:227], v4 offset:56064
  v_fma_f32 v239, v239, v239, 1.0
  v_fma_f32 v240, v240, v240, 1.0
  v_fma_f32 v241, v241, v241, 1.0
  v_fma_f32 v242, v242, v242, 1.0
  v_fma_f32 v243, v243, v243, 1.0
  v_mfma_f32_32x32x16_bf16 v[172:187], v[208:211], v[108:111], v[172:187]
  ds_read_b64_tr_b16 v[204:205], v5 offset:25600
  ds_read_b64_tr_b16 v[206:207], v5 offset:54272
  v_add_u32 v253, 4096, v253
  global_load_dwordx4 a[160:163], v253, s[68:69] offset:0 sc1
  v_rcp_f32 v236, v236
  v_rcp_f32 v237, v237
  s_waitcnt lgkmcnt(6)
  v_mfma_f32_32x32x16_bf16 v[172:187], v[212:215], v[112:115], v[172:187]
  ds_read_b64_tr_b16 v[208:209], v5 offset:27392
  ds_read_b64_tr_b16 v[210:211], v5 offset:56064
  v_rcp_f32 v238, v238
  v_rcp_f32 v239, v239
  v_rcp_f32 v240, v240
  v_mfma_f32_32x32x16_bf16 v[172:187], v[216:219], v[116:119], v[172:187]
  global_load_dwordx4 a[164:167], v253, s[68:69] offset:1024 sc1
  v_rcp_f32 v241, v241
  v_rcp_f32 v242, v242
  s_waitcnt lgkmcnt(6)
  v_mfma_f32_32x32x16_bf16 v[172:187], v[220:223], v[120:123], v[172:187]
  v_rcp_f32 v243, v243
  v_fmaak_f32 v236, v236, v252, 0x3f317218
  v_fmaak_f32 v237, v237, v252, 0x3f317218
  s_waitcnt lgkmcnt(4)
  v_mfma_f32_32x32x16_bf16 v[172:187], v[224:227], v[124:127], v[172:187]
  global_load_dwordx4 a[168:171], v253, s[68:69] offset:2048 sc1
  v_fmaak_f32 v238, v238, v252, 0x3f317218
  v_fmaak_f32 v239, v239, v252, 0x3f317218
  v_fmaak_f32 v240, v240, v252, 0x3f317218
  v_fmaak_f32 v241, v241, v252, 0x3f317218
  v_fmaak_f32 v242, v242, v252, 0x3f317218
  s_waitcnt lgkmcnt(2)
  v_mfma_f32_32x32x16_bf16 v[172:187], v[204:207], v[128:131], v[172:187]
  v_fmaak_f32 v243, v243, v252, 0x3f317218
  v_mul_f32 v228, v228, v236
  v_mul_f32 v229, v229, v237
  v_mul_f32 v230, v230, v238
  v_mul_f32 v231, v231, v239
  s_waitcnt lgkmcnt(0)
  v_mfma_f32_32x32x16_bf16 v[172:187], v[208:211], v[132:135], v[172:187]
  global_load_dwordx4 a[172:175], v253, s[68:69] offset:3072 sc1
  v_mul_f32 v232, v232, v240
  v_mul_f32 v233, v233, v241
  v_mul_f32 v234, v234, v242
  v_mul_f32 v235, v235, v243
  v_mfma_f32_32x32x16_bf16 v[172:187], a[232:235], v[136:139], v[172:187]
  v_cvt_pk_bf16_f32 v244, v228, v229
  v_cvt_pk_bf16_f32 v245, v230, v231
  v_cvt_pk_bf16_f32 v246, v232, v233
  v_cvt_pk_bf16_f32 v247, v234, v235
  global_store_dwordx4 v249, v[244:247], s[32:33] offset:-2048 sc1
  ds_read_b64_tr_b16 v[204:205], v6 offset:768
  ds_read_b64_tr_b16 v[206:207], v6 offset:29440
  ds_read_b64_tr_b16 v[208:209], v6 offset:2560
  ds_read_b64_tr_b16 v[210:211], v6 offset:31232
  ds_read_b64_tr_b16 v[212:213], v7 offset:768
  ds_read_b64_tr_b16 v[214:215], v7 offset:29440
  ds_read_b64_tr_b16 v[216:217], v7 offset:2560
  ds_read_b64_tr_b16 v[218:219], v7 offset:31232
  ds_read_b64_tr_b16 v[220:221], v6 offset:4352
  ds_read_b64_tr_b16 v[222:223], v6 offset:33024
  s_waitcnt lgkmcnt(6)
  v_mfma_f32_32x32x16_bf16 v[188:203], v[204:207], v[8:11], 0
  ds_read_b64_tr_b16 v[224:225], v6 offset:6144
  ds_read_b64_tr_b16 v[226:227], v6 offset:34816
  v_mul_f32 v228, v156, v251
  v_mul_f32 v229, v157, v251
  v_mul_f32 v230, v158, v251
  v_mul_f32 v231, v159, v251
  v_mul_f32 v232, v160, v251
  v_mfma_f32_32x32x16_bf16 v[188:203], v[208:211], v[12:15], v[188:203]
  ds_read_b64_tr_b16 v[204:205], v7 offset:4352
  ds_read_b64_tr_b16 v[206:207], v7 offset:33024
  v_add_u32 v253, 4096, v253
  global_load_dwordx4 a[176:179], v253, s[68:69] offset:0 sc1
  v_mul_f32 v233, v161, v251
  v_mul_f32 v234, v162, v251
  v_mul_f32 v235, v163, v251
  v_exp_f32 v236, v228
  s_waitcnt lgkmcnt(6)
  v_mfma_f32_32x32x16_bf16 v[188:203], v[212:215], v[16:19], v[188:203]
  ds_read_b64_tr_b16 v[208:209], v7 offset:6144
  ds_read_b64_tr_b16 v[210:211], v7 offset:34816
  v_exp_f32 v237, v229
  v_exp_f32 v238, v230
  v_mfma_f32_32x32x16_bf16 v[188:203], v[216:219], v[20:23], v[188:203]
  ds_read_b64_tr_b16 v[212:213], v6 offset:7936
  ds_read_b64_tr_b16 v[214:215], v6 offset:36608
  global_load_dwordx4 a[180:183], v253, s[68:69] offset:1024 sc1
  v_exp_f32 v239, v231
  v_exp_f32 v240, v232
  s_waitcnt lgkmcnt(6)
  v_mfma_f32_32x32x16_bf16 v[188:203], v[220:223], v[24:27], v[188:203]
  ds_read_b64_tr_b16 v[216:217], v6 offset:9728
  ds_read_b64_tr_b16 v[218:219], v6 offset:38400
  v_exp_f32 v241, v233
  v_exp_f32 v242, v234
  v_exp_f32 v243, v235
  v_mfma_f32_32x32x16_bf16 v[188:203], v[224:227], v[28:31], v[188:203]
  ds_read_b64_tr_b16 v[220:221], v7 offset:7936
  ds_read_b64_tr_b16 v[222:223], v7 offset:36608
  global_load_dwordx4 a[184:187], v253, s[68:69] offset:2048 sc1
  v_add_f32 v236, 1.0, v236
  v_add_f32 v237, 1.0, v237
  v_add_f32 v238, 1.0, v238
  v_add_f32 v239, 1.0, v239
  s_waitcnt lgkmcnt(6)
  v_mfma_f32_32x32x16_bf16 v[188:203], v[204:207], v[32:35], v[188:203]
  ds_read_b64_tr_b16 v[224:225], v7 offset:9728
  ds_read_b64_tr_b16 v[226:227], v7 offset:38400
  v_add_f32 v240, 1.0, v240
  v_add_f32 v241, 1.0, v241
  v_add_f32 v242, 1.0, v242
  v_add_f32 v243, 1.0, v243
  v_fma_f32 v236, v236, v236, 1.0
  v_mfma_f32_32x32x16_bf16 v[188:203], v[208:211], v[36:39], v[188:203]
  ds_read_b64_tr_b16 v[204:205], v6 offset:11520
  ds_read_b64_tr_b16 v[206:207], v6 offset:40192
  global_load_dwordx4 a[188:191], v253, s[68:69] offset:3072 sc1
  v_fma_f32 v237, v237, v237, 1.0
  v_fma_f32 v238, v238, v238, 1.0
  v_fma_f32 v239, v239, v239, 1.0
  v_fma_f32 v240, v240, v240, 1.0
  s_waitcnt lgkmcnt(6)
  v_mfma_f32_32x32x16_bf16 v[188:203], v[212:215], v[40:43], v[188:203]
  ds_read_b64_tr_b16 v[208:209], v6 offset:13312
  ds_read_b64_tr_b16 v[210:211], v6 offset:41984
  v_fma_f32 v241, v241, v241, 1.0
  v_fma_f32 v242, v242, v242, 1.0
  v_fma_f32 v243, v243, v243, 1.0
  v_rcp_f32 v236, v236
  v_mfma_f32_32x32x16_bf16 v[188:203], v[216:219], v[44:47], v[188:203]
  ds_read_b64_tr_b16 v[212:213], v7 offset:11520
  ds_read_b64_tr_b16 v[214:215], v7 offset:40192
  v_add_u32 v253, 4096, v253
  global_load_dwordx4 a[192:195], v253, s[68:69] offset:0 sc1
  v_rcp_f32 v237, v237
  v_rcp_f32 v238, v238
  s_waitcnt lgkmcnt(6)
  v_mfma_f32_32x32x16_bf16 v[188:203], v[220:223], v[48:51], v[188:203]
  ds_read_b64_tr_b16 v[216:217], v7 offset:13312
  ds_read_b64_tr_b16 v[218:219], v7 offset:41984
  v_rcp_f32 v239, v239
  v_rcp_f32 v240, v240
  v_rcp_f32 v241, v241
  v_mfma_f32_32x32x16_bf16 v[188:203], v[224:227], v[52:55], v[188:203]
  ds_read_b64_tr_b16 v[220:221], v6 offset:15104
  ds_read_b64_tr_b16 v[222:223], v6 offset:43776
  global_load_dwordx4 a[196:199], v253, s[68:69] offset:1024 sc1
  v_rcp_f32 v242, v242
  v_rcp_f32 v243, v243
  s_waitcnt lgkmcnt(6)
  v_mfma_f32_32x32x16_bf16 v[188:203], v[204:207], v[56:59], v[188:203]
  ds_read_b64_tr_b16 v[224:225], v6 offset:16896
  ds_read_b64_tr_b16 v[226:227], v6 offset:45568
  v_fmaak_f32 v236, v236, v252, 0x3f317218
  v_fmaak_f32 v237, v237, v252, 0x3f317218
  v_fmaak_f32 v238, v238, v252, 0x3f317218
  v_fmaak_f32 v239, v239, v252, 0x3f317218
  v_fmaak_f32 v240, v240, v252, 0x3f317218
  v_mfma_f32_32x32x16_bf16 v[188:203], v[208:211], v[60:63], v[188:203]
  ds_read_b64_tr_b16 v[204:205], v7 offset:15104
  ds_read_b64_tr_b16 v[206:207], v7 offset:43776
  global_load_dwordx4 a[200:203], v253, s[68:69] offset:2048 sc1
  v_fmaak_f32 v241, v241, v252, 0x3f317218
  v_fmaak_f32 v242, v242, v252, 0x3f317218
  v_fmaak_f32 v243, v243, v252, 0x3f317218
  v_mul_f32 v228, v228, v236
  s_waitcnt lgkmcnt(6)
  v_mfma_f32_32x32x16_bf16 v[188:203], v[212:215], v[64:67], v[188:203]
  ds_read_b64_tr_b16 v[208:209], v7 offset:16896
  ds_read_b64_tr_b16 v[210:211], v7 offset:45568
  v_mul_f32 v229, v229, v237
  v_mul_f32 v230, v230, v238
  v_mul_f32 v231, v231, v239
  v_mul_f32 v232, v232, v240
  v_mul_f32 v233, v233, v241
  v_mfma_f32_32x32x16_bf16 v[188:203], v[216:219], v[68:71], v[188:203]
  ds_read_b64_tr_b16 v[212:213], v6 offset:18688
  ds_read_b64_tr_b16 v[214:215], v6 offset:47360
  global_load_dwordx4 a[204:207], v253, s[68:69] offset:3072 sc1
  v_mul_f32 v234, v234, v242
  v_mul_f32 v235, v235, v243
  v_cvt_pk_bf16_f32 v244, v228, v229
  v_cvt_pk_bf16_f32 v245, v230, v231
  v_cvt_pk_bf16_f32 v246, v232, v233
  s_waitcnt lgkmcnt(6)
  v_mfma_f32_32x32x16_bf16 v[188:203], v[220:223], v[72:75], v[188:203]
  ds_read_b64_tr_b16 v[216:217], v6 offset:20480
  ds_read_b64_tr_b16 v[218:219], v6 offset:49152
  v_cvt_pk_bf16_f32 v247, v234, v235
  v_mfma_f32_32x32x16_bf16 v[188:203], v[224:227], v[76:79], v[188:203]
  ds_read_b64_tr_b16 v[220:221], v7 offset:18688
  ds_read_b64_tr_b16 v[222:223], v7 offset:47360
  v_add_u32 v253, 4096, v253
  global_load_dwordx4 a[208:211], v253, s[68:69] offset:0 sc1
  global_store_dwordx4 v249, v[244:247], s[32:33] offset:-1024 sc1
  v_mul_f32 v228, v164, v251
  v_mul_f32 v229, v165, v251
  v_mul_f32 v230, v166, v251
  v_mul_f32 v231, v167, v251
  v_mul_f32 v232, v168, v251
  v_mul_f32 v233, v169, v251
  v_mul_f32 v234, v170, v251
  s_waitcnt lgkmcnt(6)
  v_mfma_f32_32x32x16_bf16 v[188:203], v[204:207], v[80:83], v[188:203]
  ds_read_b64_tr_b16 v[224:225], v7 offset:20480
  ds_read_b64_tr_b16 v[226:227], v7 offset:49152
  v_mul_f32 v235, v171, v251
  v_exp_f32 v236, v228
  v_exp_f32 v237, v229
  v_mfma_f32_32x32x16_bf16 v[188:203], v[208:211], v[84:87], v[188:203]
  ds_read_b64_tr_b16 v[204:205], v6 offset:22272
  ds_read_b64_tr_b16 v[206:207], v6 offset:50944
  global_load_dwordx4 a[212:215], v253, s[68:69] offset:1024 sc1
  v_exp_f32 v238, v230
  v_exp_f32 v239, v231
  s_waitcnt lgkmcnt(6)
  v_mfma_f32_32x32x16_bf16 v[188:203], v[212:215], v[88:91], v[188:203]
  ds_read_b64_tr_b16 v[208:209], v6 offset:24064
  ds_read_b64_tr_b16 v[210:211], v6 offset:52736
  v_exp_f32 v240, v232
  v_exp_f32 v241, v233
  v_exp_f32 v242, v234
  v_mfma_f32_32x32x16_bf16 v[188:203], v[216:219], v[92:95], v[188:203]
  ds_read_b64_tr_b16 v[212:213], v7 offset:22272
  ds_read_b64_tr_b16 v[214:215], v7 offset:50944
  global_load_dwordx4 a[216:219], v253, s[68:69] offset:2048 sc1
  v_exp_f32 v243, v235
  v_add_f32 v236, 1.0, v236
  v_add_f32 v237, 1.0, v237
  s_waitcnt lgkmcnt(6)
  v_mfma_f32_32x32x16_bf16 v[188:203], v[220:223], v[96:99], v[188:203]
  ds_read_b64_tr_b16 v[216:217], v7 offset:24064
  ds_read_b64_tr_b16 v[218:219], v7 offset:52736
  v_add_f32 v238, 1.0, v238
  v_add_f32 v239, 1.0, v239
  v_add_f32 v240, 1.0, v240
  v_add_f32 v241, 1.0, v241
  v_mfma_f32_32x32x16_bf16 v[188:203], v[224:227], v[100:103], v[188:203]
  ds_read_b64_tr_b16 v[220:221], v6 offset:25856
  ds_read_b64_tr_b16 v[222:223], v6 offset:54528
  global_load_dwordx4 a[220:223], v253, s[68:69] offset:3072 sc1
  v_add_f32 v242, 1.0, v242
  v_add_f32 v243, 1.0, v243
  v_fma_f32 v236, v236, v236, 1.0
  v_fma_f32 v237, v237, v237, 1.0
  v_fma_f32 v238, v238, v238, 1.0
  s_waitcnt lgkmcnt(6)
  v_mfma_f32_32x32x16_bf16 v[188:203], v[204:207], v[104:107], v[188:203]
  ds_read_b64_tr_b16 v[224:225], v6 offset:27648
  ds_read_b64_tr_b16 v[226:227], v6 offset:56320
  v_fma_f32 v239, v239, v239, 1.0
  v_fma_f32 v240, v240, v240, 1.0
  v_fma_f32 v241, v241, v241, 1.0
  v_fma_f32 v242, v242, v242, 1.0
  v_fma_f32 v243, v243, v243, 1.0
  v_mfma_f32_32x32x16_bf16 v[188:203], v[208:211], v[108:111], v[188:203]
  ds_read_b64_tr_b16 v[204:205], v7 offset:25856
  ds_read_b64_tr_b16 v[206:207], v7 offset:54528
  v_rcp_f32 v236, v236
  v_rcp_f32 v237, v237
  s_waitcnt lgkmcnt(6)
  v_mfma_f32_32x32x16_bf16 v[188:203], v[212:215], v[112:115], v[188:203]
  ds_read_b64_tr_b16 v[208:209], v7 offset:27648
  ds_read_b64_tr_b16 v[210:211], v7 offset:56320
  v_rcp_f32 v238, v238
  v_rcp_f32 v239, v239
  v_rcp_f32 v240, v240
  v_mfma_f32_32x32x16_bf16 v[188:203], v[216:219], v[116:119], v[188:203]
  v_rcp_f32 v241, v241
  v_rcp_f32 v242, v242
  s_waitcnt lgkmcnt(6)
  v_mfma_f32_32x32x16_bf16 v[188:203], v[220:223], v[120:123], v[188:203]
  v_rcp_f32 v243, v243
  v_fmaak_f32 v236, v236, v252, 0x3f317218
  v_fmaak_f32 v237, v237, v252, 0x3f317218
  s_waitcnt lgkmcnt(4)
  v_mfma_f32_32x32x16_bf16 v[188:203], v[224:227], v[124:127], v[188:203]
  v_fmaak_f32 v238, v238, v252, 0x3f317218
  v_fmaak_f32 v239, v239, v252, 0x3f317218
  v_fmaak_f32 v240, v240, v252, 0x3f317218
  v_fmaak_f32 v241, v241, v252, 0x3f317218
  v_fmaak_f32 v242, v242, v252, 0x3f317218
  s_waitcnt lgkmcnt(2)
  v_mfma_f32_32x32x16_bf16 v[188:203], v[204:207], v[128:131], v[188:203]
  v_fmaak_f32 v243, v243, v252, 0x3f317218
  v_mul_f32 v228, v228, v236
  v_mul_f32 v229, v229, v237
  v_mul_f32 v230, v230, v238
  v_mul_f32 v231, v231, v239
  s_waitcnt lgkmcnt(0)
  v_mfma_f32_32x32x16_bf16 v[188:203], v[208:211], v[132:135], v[188:203]
  v_mul_f32 v232, v232, v240
  v_mul_f32 v233, v233, v241
  v_mul_f32 v234, v234, v242
  v_mul_f32 v235, v235, v243
  v_mfma_f32_32x32x16_bf16 v[188:203], a[236:239], v[136:139], v[188:203]
  v_cvt_pk_bf16_f32 v244, v228, v229
  v_cvt_pk_bf16_f32 v245, v230, v231
  v_cvt_pk_bf16_f32 v246, v232, v233
  v_cvt_pk_bf16_f32 v247, v234, v235
  global_store_dwordx4 v249, v[244:247], s[32:33] offset:0 sc1
  v_mul_f32 v228, v172, v251
  v_mul_f32 v229, v173, v251
  v_mul_f32 v230, v174, v251
  v_mul_f32 v231, v175, v251
  v_mul_f32 v232, v176, v251
  v_mul_f32 v233, v177, v251
  v_mul_f32 v234, v178, v251
  v_mul_f32 v235, v179, v251
  v_exp_f32 v236, v228
  v_exp_f32 v237, v229
  v_exp_f32 v238, v230
  v_exp_f32 v239, v231
  v_exp_f32 v240, v232
  v_exp_f32 v241, v233
  v_exp_f32 v242, v234
  v_exp_f32 v243, v235
  v_add_f32 v236, 1.0, v236
  v_add_f32 v237, 1.0, v237
  v_add_f32 v238, 1.0, v238
  v_add_f32 v239, 1.0, v239
  v_add_f32 v240, 1.0, v240
  v_add_f32 v241, 1.0, v241
  v_add_f32 v242, 1.0, v242
  v_add_f32 v243, 1.0, v243
  v_fma_f32 v236, v236, v236, 1.0
  v_fma_f32 v237, v237, v237, 1.0
  v_fma_f32 v238, v238, v238, 1.0
  v_fma_f32 v239, v239, v239, 1.0
  v_fma_f32 v240, v240, v240, 1.0
  v_fma_f32 v241, v241, v241, 1.0
  v_fma_f32 v242, v242, v242, 1.0
  v_fma_f32 v243, v243, v243, 1.0
  v_rcp_f32 v236, v236
  v_rcp_f32 v237, v237
  v_rcp_f32 v238, v238
  v_rcp_f32 v239, v239
  v_rcp_f32 v240, v240
  v_rcp_f32 v241, v241
  v_rcp_f32 v242, v242
  v_rcp_f32 v243, v243
  v_fmaak_f32 v236, v236, v252, 0x3f317218
  v_fmaak_f32 v237, v237, v252, 0x3f317218
  v_fmaak_f32 v238, v238, v252, 0x3f317218
  v_fmaak_f32 v239, v239, v252, 0x3f317218
  v_fmaak_f32 v240, v240, v252, 0x3f317218
  v_fmaak_f32 v241, v241, v252, 0x3f317218
  v_fmaak_f32 v242, v242, v252, 0x3f317218
  v_fmaak_f32 v243, v243, v252, 0x3f317218
  v_mul_f32 v228, v228, v236
  v_mul_f32 v229, v229, v237
  v_mul_f32 v230, v230, v238
  v_mul_f32 v231, v231, v239
  v_mul_f32 v232, v232, v240
  v_mul_f32 v233, v233, v241
  v_mul_f32 v234, v234, v242
  v_mul_f32 v235, v235, v243
  v_cvt_pk_bf16_f32 v244, v228, v229
  v_cvt_pk_bf16_f32 v245, v230, v231
  v_cvt_pk_bf16_f32 v246, v232, v233
  v_cvt_pk_bf16_f32 v247, v234, v235
  global_store_dwordx4 v249, v[244:247], s[32:33] offset:1024 sc1
  s_waitcnt vmcnt(5)
  s_waitcnt lgkmcnt(0)
  s_barrier
  s_cmp_eq_u32 s40, 0
  s_cbranch_scc0 B4A_NOARR
  s_lshl_b32 s48, s47, 3
  s_add_u32 s48, s48, s41
  s_add_u32 s48, s48, 80
  s_lshl_b32 s48, s48, 8
  v_mov_b32 v255, s48
  v_mov_b32 v254, 1
  s_mov_b64 exec, 1
  global_atomic_add v255, v254, s[34:35] sc1
  s_mov_b64 exec, -1
B4A_NOARR:
  v_mul_f32 v228, v180, v251
  v_mul_f32 v229, v181, v251
  v_mul_f32 v230, v182, v251
  v_mul_f32 v231, v183, v251
  v_mul_f32 v232, v184, v251
  v_mul_f32 v233, v185, v251
  v_mul_f32 v234, v186, v251
  v_mul_f32 v235, v187, v251
  v_exp_f32 v236, v228
  v_exp_f32 v237, v229
  v_exp_f32 v238, v230
  v_exp_f32 v239, v231
  v_exp_f32 v240, v232
  v_exp_f32 v241, v233
  v_exp_f32 v242, v234
  v_exp_f32 v243, v235
  v_add_f32 v236, 1.0, v236
  v_add_f32 v237, 1.0, v237
  v_add_f32 v238, 1.0, v238
  v_add_f32 v239, 1.0, v239
  v_add_f32 v240, 1.0, v240
  v_add_f32 v241, 1.0, v241
  v_add_f32 v242, 1.0, v242
  v_add_f32 v243, 1.0, v243
  v_fma_f32 v236, v236, v236, 1.0
  v_fma_f32 v237, v237, v237, 1.0
  v_fma_f32 v238, v238, v238, 1.0
  v_fma_f32 v239, v239, v239, 1.0
  v_fma_f32 v240, v240, v240, 1.0
  v_fma_f32 v241, v241, v241, 1.0
  v_fma_f32 v242, v242, v242, 1.0
  v_fma_f32 v243, v243, v243, 1.0
  v_rcp_f32 v236, v236
  v_rcp_f32 v237, v237
  v_rcp_f32 v238, v238
  v_rcp_f32 v239, v239
  v_rcp_f32 v240, v240
  v_rcp_f32 v241, v241
  v_rcp_f32 v242, v242
  v_rcp_f32 v243, v243
  v_fmaak_f32 v236, v236, v252, 0x3f317218
  v_fmaak_f32 v237, v237, v252, 0x3f317218
  v_fmaak_f32 v238, v238, v252, 0x3f317218
  v_fmaak_f32 v239, v239, v252, 0x3f317218
  v_fmaak_f32 v240, v240, v252, 0x3f317218
  v_fmaak_f32 v241, v241, v252, 0x3f317218
  v_fmaak_f32 v242, v242, v252, 0x3f317218
  v_fmaak_f32 v243, v243, v252, 0x3f317218
  v_mul_f32 v228, v228, v236
  v_mul_f32 v229, v229, v237
  v_mul_f32 v230, v230, v238
  v_mul_f32 v231, v231, v239
  v_mul_f32 v232, v232, v240
  v_mul_f32 v233, v233, v241
  v_mul_f32 v234, v234, v242
  v_mul_f32 v235, v235, v243
  v_cvt_pk_bf16_f32 v244, v228, v229
  v_cvt_pk_bf16_f32 v245, v230, v231
  v_cvt_pk_bf16_f32 v246, v232, v233
  v_cvt_pk_bf16_f32 v247, v234, v235
  global_store_dwordx4 v249, v[244:247], s[32:33] offset:2048 sc1
  v_mul_f32 v228, v188, v251
  v_mul_f32 v229, v189, v251
  v_mul_f32 v230, v190, v251
  v_mul_f32 v231, v191, v251
  v_mul_f32 v232, v192, v251
  v_mul_f32 v233, v193, v251
  v_mul_f32 v234, v194, v251
  v_mul_f32 v235, v195, v251
  v_exp_f32 v236, v228
  v_exp_f32 v237, v229
  v_exp_f32 v238, v230
  v_exp_f32 v239, v231
  v_exp_f32 v240, v232
  v_exp_f32 v241, v233
  v_exp_f32 v242, v234
  v_exp_f32 v243, v235
  v_add_f32 v236, 1.0, v236
  v_add_f32 v237, 1.0, v237
  v_add_f32 v238, 1.0, v238
  v_add_f32 v239, 1.0, v239
  v_add_f32 v240, 1.0, v240
  v_add_f32 v241, 1.0, v241
  v_add_f32 v242, 1.0, v242
  v_add_f32 v243, 1.0, v243
  v_fma_f32 v236, v236, v236, 1.0
  v_fma_f32 v237, v237, v237, 1.0
  v_fma_f32 v238, v238, v238, 1.0
  v_fma_f32 v239, v239, v239, 1.0
  v_fma_f32 v240, v240, v240, 1.0
  v_fma_f32 v241, v241, v241, 1.0
  v_fma_f32 v242, v242, v242, 1.0
  v_fma_f32 v243, v243, v243, 1.0
  v_rcp_f32 v236, v236
  v_rcp_f32 v237, v237
  v_rcp_f32 v238, v238
  v_rcp_f32 v239, v239
  v_rcp_f32 v240, v240
  v_rcp_f32 v241, v241
  v_rcp_f32 v242, v242
  v_rcp_f32 v243, v243
  v_fmaak_f32 v236, v236, v252, 0x3f317218
  v_fmaak_f32 v237, v237, v252, 0x3f317218
  v_fmaak_f32 v238, v238, v252, 0x3f317218
  v_fmaak_f32 v239, v239, v252, 0x3f317218
  v_fmaak_f32 v240, v240, v252, 0x3f317218
  v_fmaak_f32 v241, v241, v252, 0x3f317218
  v_fmaak_f32 v242, v242, v252, 0x3f317218
  v_fmaak_f32 v243, v243, v252, 0x3f317218
  v_mul_f32 v228, v228, v236
  v_mul_f32 v229, v229, v237
  v_mul_f32 v230, v230, v238
  v_mul_f32 v231, v231, v239
  v_mul_f32 v232, v232, v240
  v_mul_f32 v233, v233, v241
  v_mul_f32 v234, v234, v242
  v_mul_f32 v235, v235, v243
  v_cvt_pk_bf16_f32 v244, v228, v229
  v_cvt_pk_bf16_f32 v245, v230, v231
  v_cvt_pk_bf16_f32 v246, v232, v233
  v_cvt_pk_bf16_f32 v247, v234, v235
  global_store_dwordx4 v249, v[244:247], s[32:33] offset:3072 sc1
  s_lshl_b32 s48, s47, 3
  s_add_u32 s48, s48, s41
  s_add_u32 s48, s48, 80
  s_lshl_b32 s48, s48, 8
  v_mov_b32 v255, s48
  global_load_dword v254, v255, s[34:35] sc1
  s_lshl_b32 s48, s47, 5
  s_add_u32 s48, s48, s41
  s_lshr_b32 s49, s44, 3
  s_lshl_b32 s49, s49, 4
  s_add_u32 s56, s48, s49
  s_and_b32 s57, s40, 1
  s_lshr_b32 s58, s40, 1
  s_and_b32 s50, s44, 1
  s_xor_b32 s58, s58, s50
  s_lshl_b32 s48, s58, 3
  s_add_u32 s59, s56, s48
  s_xor_b32 s48, s48, 8
  s_add_u32 s55, s56, s48
  s_mul_i32 s49, s40, 28672
  s_add_u32 s49, s49, 3072
  s_mul_i32 s48, s55, 114688
  s_add_u32 s48, s48, s49
  v_lshl_add_u32 v204, v1, 4, s48
  v_add_u32 v205, 7168, v204
  v_add_u32 v206, 14336, v204
  v_add_u32 v207, 21504, v204
  s_mul_i32 s48, s59, 114688
  s_add_u32 s48, s48, s49
  v_lshl_add_u32 v208, v1, 4, s48
  v_add_u32 v209, 7168, v208
  v_add_u32 v210, 14336, v208
  v_add_u32 v211, 21504, v208
  s_and_b32 s60, s44, 7
  s_and_b32 s48, s60, 1
  s_lshl_b32 s48, s48, 1
  s_add_u32 s48, s48, s57
  s_lshl_b32 s48, s48, 13
  s_lshr_b32 s49, s60, 2
  s_lshl_b32 s49, s49, 11
  s_add_u32 s48, s48, s49
  s_bfe_u32 s49, s60, 0x10001
  s_lshl_b32 s49, s49, 3
  s_add_u32 s48, s48, s49
  s_lshl_b32 s49, s59, 15
  s_add_u32 s48, s48, s49
  s_add_u32 s48, s48, 2048
  v_lshl_add_u32 v212, v1, 4, s48
  global_load_dwordx2 v[216:217], v212, s[28:29] offset:-2048 sc1
  global_load_dwordx2 v[218:219], v212, s[28:29] offset:-1024 sc1
  global_load_dwordx2 v[220:221], v212, s[28:29] offset:2048 sc1
  global_load_dwordx2 v[222:223], v212, s[28:29] offset:3072 sc1
  s_lshl_b32 s48, s59, 10
  s_lshl_b32 s49, s60, 7
  s_add_u32 s48, s48, s49
  s_lshl_b32 s49, s57, 6
  s_add_u32 s48, s48, s49
  v_and_b32 v4, 31, v1
  v_lshlrev_b32 v4, 16, v4
  v_lshrrev_b32 v5, 5, v1
  v_lshl_add_u32 v4, v5, 4, v4
  v_add_u32 v213, s48, v4
  v_lshlrev_b32 v214, 4, v1
  s_xor_b32 s52, s40, 3
  s_sub_u32 s48, s40, s52
  s_sub_u32 s48, s48, 1
  s_and_b32 s48, s48, 3
  s_lshl_b32 s48, s48, 12
  s_mul_i32 s52, s52, 12288
  s_add_u32 s48, s48, s52
  v_add_u32 v6, s48, v214
  s_xor_b32 s52, s40, 2
  s_sub_u32 s49, s40, s52
  s_sub_u32 s49, s49, 1
  s_and_b32 s49, s49, 3
  s_lshl_b32 s49, s49, 12
  s_mul_i32 s52, s52, 12288
  s_add_u32 s49, s49, s52
  v_add_u32 v7, s49, v214
  s_xor_b32 s52, s40, 1
  s_sub_u32 s50, s40, s52
  s_sub_u32 s50, s50, 1
  s_and_b32 s50, s50, 3
  s_lshl_b32 s50, s50, 12
  s_mul_i32 s52, s52, 12288
  s_add_u32 s50, s50, s52
  v_add_u32 v8, s50, v214
  s_mul_i32 s48, s40, 12288
  v_add_u32 v9, s48, v214
  s_lshl_b32 s48, s47, 3
  s_add_u32 s48, s48, s41
  s_add_u32 s48, s48, 96
  s_lshl_b32 s48, s48, 8
  v_mov_b32 v215, s48
  s_waitcnt vmcnt(4)
  v_cmp_le_u32 vcc, 16, v254
  s_nop 4
  s_cbranch_vccnz B4A_OK
  s_mov_b32 s71, 0
B4A_POLL:
  s_add_u32 s71, s71, 1
  s_cmp_gt_u32 s71, 0x100000
  s_cbranch_scc1 L_END
  global_load_dword v254, v255, s[34:35] sc1
  s_waitcnt vmcnt(0)
  v_cmp_le_u32 vcc, 16, v254
  s_nop 4
  s_cbranch_vccz B4A_POLL
B4A_OK:
  global_load_dwordx4 v[76:79], v204, s[32:33] offset:-3072 sc1
  global_load_dwordx4 v[80:83], v204, s[32:33] offset:-2048 sc1
  global_load_dwordx4 v[84:87], v204, s[32:33] offset:-1024 sc1
  global_load_dwordx4 v[88:91], v205, s[32:33] offset:-3072 sc1
  global_load_dwordx4 v[92:95], v205, s[32:33] offset:-2048 sc1
  global_load_dwordx4 v[96:99], v205, s[32:33] offset:-1024 sc1
  global_load_dwordx4 v[100:103], v206, s[32:33] offset:-3072 sc1
  global_load_dwordx4 v[104:107], v206, s[32:33] offset:-2048 sc1
  s_waitcnt lgkmcnt(0)
  s_barrier
  s_cmp_eq_u32 s40, 0
  s_cbranch_scc0 B4B_NOARR
  s_lshl_b32 s48, s47, 3
  s_add_u32 s48, s48, s41
  s_add_u32 s48, s48, 96
  s_lshl_b32 s48, s48, 8
  v_mov_b32 v255, s48
  v_mov_b32 v254, 1
  s_mov_b64 exec, 1
  global_atomic_add v255, v254, s[34:35] sc1
  s_mov_b64 exec, -1
B4B_NOARR:
  s_waitcnt vmcnt(7)
  v_mfma_f32_32x32x16_bf16 v[12:27], a[0:3], v[76:79], 0
  v_mfma_f32_32x32x16_bf16 v[28:43], a[112:115], v[76:79], 0
  global_load_dwordx4 v[108:111], v206, s[32:33] offset:-1024 sc1
  s_waitcnt vmcnt(7)
  v_mfma_f32_32x32x16_bf16 v[12:27], a[4:7], v[80:83], v[12:27]
  v_mfma_f32_32x32x16_bf16 v[28:43], a[116:119], v[80:83], v[28:43]
  global_load_dwordx4 v[112:115], v207, s[32:33] offset:-3072 sc1
  s_waitcnt vmcnt(7)
  v_mfma_f32_32x32x16_bf16 v[12:27], a[8:11], v[84:87], v[12:27]
  v_mfma_f32_32x32x16_bf16 v[28:43], a[120:123], v[84:87], v[28:43]
  global_load_dwordx4 v[116:119], v207, s[32:33] offset:-2048 sc1
  s_waitcnt vmcnt(7)
  v_mfma_f32_32x32x16_bf16 v[12:27], a[28:31], v[88:91], v[12:27]
  v_mfma_f32_32x32x16_bf16 v[28:43], a[140:143], v[88:91], v[28:43]
  global_load_dwordx4 v[120:123], v207, s[32:33] offset:-1024 sc1
  s_waitcnt vmcnt(7)
  v_mfma_f32_32x32x16_bf16 v[12:27], a[32:35], v[92:95], v[12:27]
  v_mfma_f32_32x32x16_bf16 v[28:43], a[144:147], v[92:95], v[28:43]
  global_load_dwordx4 v[124:127], v208, s[32:33] offset:-3072 sc1
  s_waitcnt vmcnt(7)
  v_mfma_f32_32x32x16_bf16 v[12:27], a[36:39], v[96:99], v[12:27]
  v_mfma_f32_32x32x16_bf16 v[28:43], a[148:151], v[96:99], v[28:43]
  global_load_dwordx4 v[128:131], v208, s[32:33] offset:-2048 sc1
  s_waitcnt vmcnt(7)
  v_mfma_f32_32x32x16_bf16 v[12:27], a[56:59], v[100:103], v[12:27]
  v_mfma_f32_32x32x16_bf16 v[28:43], a[168:171], v[100:103], v[28:43]
  global_load_dwordx4 v[132:135], v208, s[32:33] offset:-1024 sc1
  s_waitcnt vmcnt(7)
  v_mfma_f32_32x32x16_bf16 v[12:27], a[60:63], v[104:107], v[12:27]
  v_mfma_f32_32x32x16_bf16 v[28:43], a[172:175], v[104:107], v[28:43]
  global_load_dwordx4 v[136:139], v209, s[32:33] offset:-3072 sc1
  s_waitcnt vmcnt(7)
  v_mfma_f32_32x32x16_bf16 v[12:27], a[64:67], v[108:111], v[12:27]
  v_mfma_f32_32x32x16_bf16 v[28:43], a[176:179], v[108:111], v[28:43]
  global_load_dwordx4 v[76:79], v209, s[32:33] offset:-2048 sc1
  s_waitcnt vmcnt(7)
  v_mfma_f32_32x32x16_bf16 v[12:27], a[84:87], v[112:115], v[12:27]
  v_mfma_f32_32x32x16_bf16 v[28:43], a[196:199], v[112:115], v[28:43]
  global_load_dwordx4 v[80:83], v209, s[32:33] offset:-1024 sc1
  s_waitcnt vmcnt(7)
  v_mfma_f32_32x32x16_bf16 v[12:27], a[88:91], v[116:119], v[12:27]
  v_mfma_f32_32x32x16_bf16 v[28:43], a[200:203], v[116:119], v[28:43]
  global_load_dword v224, v215, s[34:35] sc1
  global_load_dwordx4 v[84:87], v210, s[32:33] offset:-3072 sc1
  s_waitcnt vmcnt(8)
  v_mfma_f32_32x32x16_bf16 v[12:27], a[92:95], v[120:123], v[12:27]
  v_mfma_f32_32x32x16_bf16 v[28:43], a[204:207], v[120:123], v[28:43]
  global_load_dwordx4 v[88:91], v210, s[32:33] offset:-2048 sc1
  s_waitcnt vmcnt(8)
  v_mfma_f32_32x32x16_bf16 v[44:59], a[0:3], v[124:127], 0
  v_mfma_f32_32x32x16_bf16 v[60:75], a[112:115], v[124:127], 0
  global_load_dwordx4 v[92:95], v210, s[32:33] offset:-1024 sc1
  s_waitcnt vmcnt(8)
  v_mfma_f32_32x32x16_bf16 v[44:59], a[4:7], v[128:131], v[44:59]
  v_mfma_f32_32x32x16_bf16 v[60:75], a[116:119], v[128:131], v[60:75]
  global_load_dwordx4 v[96:99], v211, s[32:33] offset:-3072 sc1
  s_waitcnt vmcnt(8)
  v_mfma_f32_32x32x16_bf16 v[44:59], a[8:11], v[132:135], v[44:59]
  v_mfma_f32_32x32x16_bf16 v[60:75], a[120:123], v[132:135], v[60:75]
  global_load_dwordx4 v[100:103], v211, s[32:33] offset:-2048 sc1
  s_waitcnt vmcnt(8)
  v_mfma_f32_32x32x16_bf16 v[44:59], a[28:31], v[136:139], v[44:59]
  v_mfma_f32_32x32x16_bf16 v[60:75], a[140:143], v[136:139], v[60:75]
  global_load_dwordx4 v[104:107], v211, s[32:33] offset:-1024 sc1
  s_waitcnt vmcnt(8)
  v_mfma_f32_32x32x16_bf16 v[44:59], a[32:35], v[76:79], v[44:59]
  v_mfma_f32_32x32x16_bf16 v[60:75], a[144:147], v[76:79], v[60:75]
  s_waitcnt vmcnt(6)
  v_cmp_le_u32 vcc, 16, v224
  s_nop 4
  s_cbranch_vccnz B4B_OK
  s_mov_b32 s71, 0
B4B_POLL:
  s_add_u32 s71, s71, 1
  s_cmp_gt_u32 s71, 0x100000
  s_cbranch_scc1 L_END
  global_load_dword v224, v215, s[34:35] sc1
  s_waitcnt vmcnt(0)
  v_cmp_le_u32 vcc, 16, v224
  s_nop 4
  s_cbranch_vccz B4B_POLL
B4B_OK:
  global_load_dwordx4 v[108:111], v204, s[32:33] offset:0 sc1
  v_mfma_f32_32x32x16_bf16 v[44:59], a[36:39], v[80:83], v[44:59]
  v_mfma_f32_32x32x16_bf16 v[60:75], a[148:151], v[80:83], v[60:75]
  global_load_dwordx4 v[112:115], v204, s[32:33] offset:1024 sc1
  s_waitcnt vmcnt(7)
  v_mfma_f32_32x32x16_bf16 v[44:59], a[56:59], v[84:87], v[44:59]
  v_mfma_f32_32x32x16_bf16 v[60:75], a[168:171], v[84:87], v[60:75]
  global_load_dwordx4 v[116:119], v204, s[32:33] offset:2048 sc1
  s_waitcnt vmcnt(7)
  v_mfma_f32_32x32x16_bf16 v[44:59], a[60:63], v[88:91], v[44:59]
  v_mfma_f32_32x32x16_bf16 v[60:75], a[172:175], v[88:91], v[60:75]
  global_load_dwordx4 v[120:123], v204, s[32:33] offset:3072 sc1
  s_waitcnt vmcnt(7)
  v_mfma_f32_32x32x16_bf16 v[44:59], a[64:67], v[92:95], v[44:59]
  v_mfma_f32_32x32x16_bf16 v[60:75], a[176:179], v[92:95], v[60:75]
  global_load_dwordx4 v[124:127], v205, s[32:33] offset:0 sc1
  s_waitcnt vmcnt(7)
  v_mfma_f32_32x32x16_bf16 v[44:59], a[84:87], v[96:99], v[44:59]
  v_mfma_f32_32x32x16_bf16 v[60:75], a[196:199], v[96:99], v[60:75]
  global_load_dwordx4 v[128:131], v205, s[32:33] offset:1024 sc1
  s_waitcnt vmcnt(7)
  v_mfma_f32_32x32x16_bf16 v[44:59], a[88:91], v[100:103], v[44:59]
  v_mfma_f32_32x32x16_bf16 v[60:75], a[200:203], v[100:103], v[60:75]
  global_load_dwordx4 v[132:135], v205, s[32:33] offset:2048 sc1
  s_waitcnt vmcnt(7)
  v_mfma_f32_32x32x16_bf16 v[44:59], a[92:95], v[104:107], v[44:59]
  v_mfma_f32_32x32x16_bf16 v[60:75], a[204:207], v[104:107], v[60:75]
  global_load_dwordx4 v[136:139], v205, s[32:33] offset:3072 sc1
  s_waitcnt vmcnt(7)
  v_mfma_f32_32x32x16_bf16 v[12:27], a[12:15], v[108:111], v[12:27]
  v_mfma_f32_32x32x16_bf16 v[28:43], a[124:127], v[108:111], v[28:43]
  global_load_dwordx4 v[76:79], v206, s[32:33] offset:0 sc1
  s_waitcnt vmcnt(7)
  v_mfma_f32_32x32x16_bf16 v[12:27], a[16:19], v[112:115], v[12:27]
  v_mfma_f32_32x32x16_bf16 v[28:43], a[128:131], v[112:115], v[28:43]
  global_load_dwordx4 v[80:83], v206, s[32:33] offset:1024 sc1
  s_waitcnt vmcnt(7)
  v_mfma_f32_32x32x16_bf16 v[12:27], a[20:23], v[116:119], v[12:27]
  v_mfma_f32_32x32x16_bf16 v[28:43], a[132:135], v[116:119], v[28:43]
  global_load_dwordx4 v[84:87], v206, s[32:33] offset:2048 sc1
  s_waitcnt vmcnt(7)
  v_mfma_f32_32x32x16_bf16 v[12:27], a[24:27], v[120:123], v[12:27]
  v_mfma_f32_32x32x16_bf16 v[28:43], a[136:139], v[120:123], v[28:43]
  global_load_dwordx4 v[88:91], v206, s[32:33] offset:3072 sc1
  s_waitcnt vmcnt(7)
  v_mfma_f32_32x32x16_bf16 v[12:27], a[40:43], v[124:127], v[12:27]
  v_mfma_f32_32x32x16_bf16 v[28:43], a[152:155], v[124:127], v[28:43]
  global_load_dwordx4 v[92:95], v207, s[32:33] offset:0 sc1
  s_waitcnt vmcnt(7)
  v_mfma_f32_32x32x16_bf16 v[12:27], a[44:47], v[128:131], v[12:27]
  v_mfma_f32_32x32x16_bf16 v[28:43], a[156:159], v[128:131], v[28:43]
  global_load_dwordx4 v[96:99], v207, s[32:33] offset:1024 sc1
  s_waitcnt vmcnt(7)
  v_mfma_f32_32x32x16_bf16 v[12:27], a[48:51], v[132:135], v[12:27]
  v_mfma_f32_32x32x16_bf16 v[28:43], a[160:163], v[132:135], v[28:43]
  global_load_dwordx4 v[100:103], v207, s[32:33] offset:2048 sc1
  s_waitcnt vmcnt(7)
  v_mfma_f32_32x32x16_bf16 v[12:27], a[52:55], v[136:139], v[12:27]
  v_mfma_f32_32x32x16_bf16 v[28:43], a[164:167], v[136:139], v[28:43]
  global_load_dwordx4 v[104:107], v207, s[32:33] offset:3072 sc1
  s_waitcnt vmcnt(7)
  v_mfma_f32_32x32x16_bf16 v[12:27], a[68:71], v[76:79], v[12:27]
  v_mfma_f32_32x32x16_bf16 v[28:43], a[180:183], v[76:79], v[28:43]
  global_load_dwordx4 v[108:111], v208, s[32:33] offset:0 sc1
  s_waitcnt vmcnt(7)
  v_mfma_f32_32x32x16_bf16 v[12:27], a[72:75], v[80:83], v[12:27]
  v_mfma_f32_32x32x16_bf16 v[28:43], a[184:187], v[80:83], v[28:43]
  global_load_dwordx4 v[112:115], v208, s[32:33] offset:1024 sc1
  s_waitcnt vmcnt(7)
  v_mfma_f32_32x32x16_bf16 v[12:27], a[76:79], v[84:87], v[12:27]
  v_mfma_f32_32x32x16_bf16 v[28:43], a[188:191], v[84:87], v[28:43]
  global_load_dwordx4 v[116:119], v208, s[32:33] offset:2048 sc1
  s_waitcnt vmcnt(7)
  v_mfma_f32_32x32x16_bf16 v[12:27], a[80:83], v[88:91], v[12:27]
  v_mfma_f32_32x32x16_bf16 v[28:43], a[192:195], v[88:91], v[28:43]
  global_load_dwordx4 v[120:123], v208, s[32:33] offset:3072 sc1
  s_waitcnt vmcnt(7)
  v_mfma_f32_32x32x16_bf16 v[12:27], a[96:99], v[92:95], v[12:27]
  v_mfma_f32_32x32x16_bf16 v[28:43], a[208:211], v[92:95], v[28:43]
  global_load_dwordx4 v[124:127], v209, s[32:33] offset:0 sc1
  s_waitcnt vmcnt(7)
  v_mfma_f32_32x32x16_bf16 v[12:27], a[100:103], v[96:99], v[12:27]
  v_mfma_f32_32x32x16_bf16 v[28:43], a[212:215], v[96:99], v[28:43]
  global_load_dwordx4 v[128:131], v209, s[32:33] offset:1024 sc1
  s_waitcnt vmcnt(7)
  v_mfma_f32_32x32x16_bf16 v[12:27], a[104:107], v[100:103], v[12:27]
  v_mfma_f32_32x32x16_bf16 v[28:43], a[216:219], v[100:103], v[28:43]
  global_load_dwordx4 v[132:135], v209, s[32:33] offset:2048 sc1
  s_waitcnt vmcnt(7)
  v_mfma_f32_32x32x16_bf16 v[12:27], a[108:111], v[104:107], v[12:27]
  v_mfma_f32_32x32x16_bf16 v[28:43], a[220:223], v[104:107], v[28:43]
  global_load_dwordx4 v[136:139], v209, s[32:33] offset:3072 sc1
  s_waitcnt vmcnt(7)
  v_mfma_f32_32x32x16_bf16 v[44:59], a[12:15], v[108:111], v[44:59]
  v_mfma_f32_32x32x16_bf16 v[60:75], a[124:127], v[108:111], v[60:75]
  global_load_dwordx4 v[76:79], v210, s[32:33] offset:0 sc1
  s_waitcnt vmcnt(7)
  v_mfma_f32_32x32x16_bf16 v[44:59], a[16:19], v[112:115], v[44:59]
  v_mfma_f32_32x32x16_bf16 v[60:75], a[128:131], v[112:115], v[60:75]
  global_load_dwordx4 v[80:83], v210, s[32:33] offset:1024 sc1
  s_nop 1
  ds_write_b128 v6, v[12:15] offset:0
  s_waitcnt vmcnt(7)
  v_mfma_f32_32x32x16_bf16 v[44:59], a[20:23], v[116:119], v[44:59]
  v_mfma_f32_32x32x16_bf16 v[60:75], a[132:135], v[116:119], v[60:75]
  global_load_dwordx4 v[84:87], v210, s[32:33] offset:2048 sc1
  ds_write_b128 v6, v[16:19] offset:1024
  s_waitcnt vmcnt(7)
  v_mfma_f32_32x32x16_bf16 v[44:59], a[24:27], v[120:123], v[44:59]
  v_mfma_f32_32x32x16_bf16 v[60:75], a[136:139], v[120:123], v[60:75]
  global_load_dwordx4 v[88:91], v210, s[32:33] offset:3072 sc1
  ds_write_b128 v6, v[20:23] offset:2048
  s_waitcnt vmcnt(7)
  v_mfma_f32_32x32x16_bf16 v[44:59], a[40:43], v[124:127], v[44:59]
  v_mfma_f32_32x32x16_bf16 v[60:75], a[152:155], v[124:127], v[60:75]
  global_load_dwordx4 v[92:95], v211, s[32:33] offset:0 sc1
  ds_write_b128 v6, v[24:27] offset:3072
  s_waitcnt vmcnt(7)
  v_mfma_f32_32x32x16_bf16 v[44:59], a[44:47], v[128:131], v[44:59]
  v_mfma_f32_32x32x16_bf16 v[60:75], a[156:159], v[128:131], v[60:75]
  global_load_dwordx4 v[96:99], v211, s[32:33] offset:1024 sc1
  ds_write_b128 v7, v[28:31] offset:0
  s_waitcnt vmcnt(7)
  v_mfma_f32_32x32x16_bf16 v[44:59], a[48:51], v[132:135], v[44:59]
  v_mfma_f32_32x32x16_bf16 v[60:75], a[160:163], v[132:135], v[60:75]
  global_load_dwordx4 v[100:103], v211, s[32:33] offset:2048 sc1
  ds_write_b128 v7, v[32:35] offset:1024
  s_waitcnt vmcnt(7)
  v_mfma_f32_32x32x16_bf16 v[44:59], a[52:55], v[136:139], v[44:59]
  v_mfma_f32_32x32x16_bf16 v[60:75], a[164:167], v[136:139], v[60:75]
  global_load_dwordx4 v[104:107], v211, s[32:33] offset:3072 sc1
  ds_write_b128 v7, v[36:39] offset:2048
  s_waitcnt vmcnt(7)
  v_mfma_f32_32x32x16_bf16 v[44:59], a[68:71], v[76:79], v[44:59]
  v_mfma_f32_32x32x16_bf16 v[60:75], a[180:183], v[76:79], v[60:75]
  ds_write_b128 v7, v[40:43] offset:3072
  s_waitcnt vmcnt(6)
  v_mfma_f32_32x32x16_bf16 v[44:59], a[72:75], v[80:83], v[44:59]
  v_mfma_f32_32x32x16_bf16 v[60:75], a[184:187], v[80:83], v[60:75]
  s_waitcnt vmcnt(5)
  v_mfma_f32_32x32x16_bf16 v[44:59], a[76:79], v[84:87], v[44:59]
  v_mfma_f32_32x32x16_bf16 v[60:75], a[188:191], v[84:87], v[60:75]
  s_waitcnt vmcnt(4)
  v_mfma_f32_32x32x16_bf16 v[44:59], a[80:83], v[88:91], v[44:59]
  v_mfma_f32_32x32x16_bf16 v[60:75], a[192:195], v[88:91], v[60:75]
  s_waitcnt vmcnt(3)
  v_mfma_f32_32x32x16_bf16 v[44:59], a[96:99], v[92:95], v[44:59]
  v_mfma_f32_32x32x16_bf16 v[60:75], a[208:211], v[92:95], v[60:75]
  s_waitcnt vmcnt(2)
  v_mfma_f32_32x32x16_bf16 v[44:59], a[100:103], v[96:99], v[44:59]
  v_mfma_f32_32x32x16_bf16 v[60:75], a[212:215], v[96:99], v[60:75]
  s_waitcnt vmcnt(1)
  v_mfma_f32_32x32x16_bf16 v[44:59], a[104:107], v[100:103], v[44:59]
  v_mfma_f32_32x32x16_bf16 v[60:75], a[216:219], v[100:103], v[60:75]
  s_waitcnt vmcnt(0)
  v_mfma_f32_32x32x16_bf16 v[44:59], a[108:111], v[104:107], v[44:59]
  v_mfma_f32_32x32x16_bf16 v[60:75], a[220:223], v[104:107], v[60:75]
  v_lshlrev_b32 v172, 16, v216
  v_and_b32 v173, 0xffff0000, v216
  v_lshlrev_b32 v174, 16, v217
  v_and_b32 v175, 0xffff0000, v217
  v_lshlrev_b32 v176, 16, v218
  v_and_b32 v177, 0xffff0000, v218
  v_lshlrev_b32 v178, 16, v219
  v_and_b32 v179, 0xffff0000, v219
  v_lshlrev_b32 v180, 16, v220
  v_and_b32 v181, 0xffff0000, v220
  v_lshlrev_b32 v182, 16, v221
  v_and_b32 v183, 0xffff0000, v221
  v_lshlrev_b32 v184, 16, v222
  v_and_b32 v185, 0xffff0000, v222
  v_lshlrev_b32 v186, 16, v223
  v_and_b32 v187, 0xffff0000, v223
  ds_write_b128 v8, v[44:47] offset:0
  ds_write_b128 v8, v[48:51] offset:1024
  ds_write_b128 v8, v[52:55] offset:2048
  ds_write_b128 v8, v[56:59] offset:3072
  v_add_f32 v60, v60, v172
  v_add_f32 v61, v61, v173
  v_add_f32 v62, v62, v174
  v_add_f32 v63, v63, v175
  v_add_f32 v64, v64, v176
  v_add_f32 v65, v65, v177
  v_add_f32 v66, v66, v178
  v_add_f32 v67, v67, v179
  v_add_f32 v68, v68, v180
  v_add_f32 v69, v69, v181
  v_add_f32 v70, v70, v182
  v_add_f32 v71, v71, v183
  v_add_f32 v72, v72, v184
  v_add_f32 v73, v73, v185
  v_add_f32 v74, v74, v186
  v_add_f32 v75, v75, v187
  s_waitcnt lgkmcnt(0)
  s_barrier
  ds_read_b128 v[76:79], v9 offset:0
  ds_read_b128 v[92:95], v9 offset:4096
  ds_read_b128 v[108:111], v9 offset:8192
  ds_read_b128 v[80:83], v9 offset:1024
  ds_read_b128 v[96:99], v9 offset:5120
  ds_read_b128 v[112:115], v9 offset:9216
  ds_read_b128 v[84:87], v9 offset:2048
  ds_read_b128 v[100:103], v9 offset:6144
  ds_read_b128 v[116:119], v9 offset:10240
  ds_read_b128 v[88:91], v9 offset:3072
  ds_read_b128 v[104:107], v9 offset:7168
  ds_read_b128 v[120:123], v9 offset:11264
  s_waitcnt lgkmcnt(10)
  v_pk_add_f32 v[76:77], v[76:77], v[92:93]
  s_waitcnt lgkmcnt(9)
  v_pk_add_f32 v[60:61], v[60:61], v[108:109]
  v_pk_add_f32 v[78:79], v[78:79], v[94:95]
  v_pk_add_f32 v[62:63], v[62:63], v[110:111]
  v_pk_add_f32 v[60:61], v[60:61], v[76:77]
  v_pk_add_f32 v[62:63], v[62:63], v[78:79]
  s_waitcnt lgkmcnt(7)
  v_pk_add_f32 v[80:81], v[80:81], v[96:97]
  s_waitcnt lgkmcnt(6)
  v_pk_add_f32 v[64:65], v[64:65], v[112:113]
  v_pk_add_f32 v[82:83], v[82:83], v[98:99]
  v_pk_add_f32 v[66:67], v[66:67], v[114:115]
  v_pk_add_f32 v[64:65], v[64:65], v[80:81]
  v_pk_add_f32 v[66:67], v[66:67], v[82:83]
  s_waitcnt lgkmcnt(4)
  v_pk_add_f32 v[84:85], v[84:85], v[100:101]
  s_waitcnt lgkmcnt(3)
  v_pk_add_f32 v[68:69], v[68:69], v[116:117]
  v_pk_add_f32 v[86:87], v[86:87], v[102:103]
  v_pk_add_f32 v[70:71], v[70:71], v[118:119]
  v_pk_add_f32 v[68:69], v[68:69], v[84:85]
  v_pk_add_f32 v[70:71], v[70:71], v[86:87]
  s_waitcnt lgkmcnt(1)
  v_pk_add_f32 v[88:89], v[88:89], v[104:105]
  s_waitcnt lgkmcnt(0)
  v_pk_add_f32 v[72:73], v[72:73], v[120:121]
  v_pk_add_f32 v[90:91], v[90:91], v[106:107]
  v_pk_add_f32 v[74:75], v[74:75], v[122:123]
  v_pk_add_f32 v[72:73], v[72:73], v[88:89]
  v_pk_add_f32 v[74:75], v[74:75], v[90:91]
  v_cvt_pk_bf16_f32 v12, v60, v61
  v_cvt_pk_bf16_f32 v13, v62, v63
  v_cvt_pk_bf16_f32 v14, v64, v65
  v_cvt_pk_bf16_f32 v15, v66, v67
  s_nop 0
  v_permlane32_swap_b32 v12, v14
  v_permlane32_swap_b32 v13, v15
  global_store_dwordx4 v213, v[12:15], s[18:19] offset:0
  v_cvt_pk_bf16_f32 v16, v68, v69
  v_cvt_pk_bf16_f32 v17, v70, v71
  v_cvt_pk_bf16_f32 v18, v72, v73
  v_cvt_pk_bf16_f32 v19, v74, v75
  s_nop 0
  v_permlane32_swap_b32 v16, v18
  v_permlane32_swap_b32 v17, v19
  global_store_dwordx4 v213, v[16:19], s[18:19] offset:32
  s_nop 1
L_END:
  s_endpgm
L_P4REDO:
  s_mov_b32 s71, 0
L_P4RE1:
  v_mov_b32 v248, v255
  global_load_dwordx4 v[8:11], v248, s[28:29] offset:0 sc1
  global_load_dwordx4 v[12:15], v248, s[28:29] offset:1024 sc1
  global_load_dwordx4 v[16:19], v248, s[28:29] offset:2048 sc1
  global_load_dwordx4 v[20:23], v248, s[28:29] offset:3072 sc1
  v_add_u32 v248, 4096, v248
  global_load_dwordx4 v[24:27], v248, s[28:29] offset:0 sc1
  global_load_dwordx4 v[28:31], v248, s[28:29] offset:1024 sc1
  global_load_dwordx4 v[32:35], v248, s[28:29] offset:2048 sc1
  global_load_dwordx4 v[36:39], v248, s[28:29] offset:3072 sc1
  v_add_u32 v248, 4096, v248
  global_load_dwordx4 v[40:43], v248, s[28:29] offset:0 sc1
  global_load_dwordx4 v[44:47], v248, s[28:29] offset:1024 sc1
  global_load_dwordx4 v[48:51], v248, s[28:29] offset:2048 sc1
  global_load_dwordx4 v[52:55], v248, s[28:29] offset:3072 sc1
  v_add_u32 v248, 4096, v248
  global_load_dwordx4 v[56:59], v248, s[28:29] offset:0 sc1
  global_load_dwordx4 v[60:63], v248, s[28:29] offset:1024 sc1
  global_load_dwordx4 v[64:67], v248, s[28:29] offset:2048 sc1
  global_load_dwordx4 v[68:71], v248, s[28:29] offset:3072 sc1
  v_add_u32 v248, 4096, v248
  global_load_dwordx4 v[72:75], v248, s[28:29] offset:0 sc1
  global_load_dwordx4 v[76:79], v248, s[28:29] offset:1024 sc1
  global_load_dwordx4 v[80:83], v248, s[28:29] offset:2048 sc1
  global_load_dwordx4 v[84:87], v248, s[28:29] offset:3072 sc1
  v_add_u32 v248, 4096, v248
  global_load_dwordx4 v[88:91], v248, s[28:29] offset:0 sc1
  global_load_dwordx4 v[92:95], v248, s[28:29] offset:1024 sc1
  global_load_dwordx4 v[96:99], v248, s[28:29] offset:2048 sc1
  global_load_dwordx4 v[100:103], v248, s[28:29] offset:3072 sc1
  v_add_u32 v248, 4096, v248
  global_load_dwordx4 v[104:107], v248, s[28:29] offset:0 sc1
  global_load_dwordx4 v[108:111], v248, s[28:29] offset:1024 sc1
  global_load_dwordx4 v[112:115], v248, s[28:29] offset:2048 sc1
  global_load_dwordx4 v[116:119], v248, s[28:29] offset:3072 sc1
  v_add_u32 v248, 4096, v248
  global_load_dwordx4 v[120:123], v248, s[28:29] offset:0 sc1
  global_load_dwordx4 v[124:127], v248, s[28:29] offset:1024 sc1
  global_load_dwordx4 v[128:131], v248, s[28:29] offset:2048 sc1
  global_load_dwordx4 v[132:135], v248, s[28:29] offset:3072 sc1
  s_waitcnt vmcnt(0)
  v_mov_b32 v254, 0
  v_max3_u32 v254, v254, v8, v11
  v_max3_u32 v254, v254, v12, v15
  v_max3_u32 v254, v254, v16, v19
  v_max3_u32 v254, v254, v20, v23
  v_max3_u32 v254, v254, v24, v27
  v_max3_u32 v254, v254, v28, v31
  v_max3_u32 v254, v254, v32, v35
  v_max3_u32 v254, v254, v36, v39
  v_max3_u32 v254, v254, v40, v43
  v_max3_u32 v254, v254, v44, v47
  v_max3_u32 v254, v254, v48, v51
  v_max3_u32 v254, v254, v52, v55
  v_max3_u32 v254, v254, v56, v59
  v_max3_u32 v254, v254, v60, v63
  v_max3_u32 v254, v254, v64, v67
  v_max3_u32 v254, v254, v68, v71
  v_max3_u32 v254, v254, v72, v75
  v_max3_u32 v254, v254, v76, v79
  v_max3_u32 v254, v254, v80, v83
  v_max3_u32 v254, v254, v84, v87
  v_max3_u32 v254, v254, v88, v91
  v_max3_u32 v254, v254, v92, v95
  v_max3_u32 v254, v254, v96, v99
  v_max3_u32 v254, v254, v100, v103
  v_max3_u32 v254, v254, v104, v107
  v_max3_u32 v254, v254, v108, v111
  v_max3_u32 v254, v254, v112, v115
  v_max3_u32 v254, v254, v116, v119
  v_max3_u32 v254, v254, v120, v123
  v_max3_u32 v254, v254, v124, v127
  v_max3_u32 v254, v254, v128, v131
  v_max3_u32 v254, v254, v132, v135
  v_cmp_eq_u32 vcc, -1, v254
  s_nop 4
  s_cbranch_vccz L_P4RE2
  s_add_u32 s71, s71, 1
  s_cmp_gt_u32 s71, 0x100000
  s_cbranch_scc0 L_P4RE1
L_P4RE2:
  ds_read_b64_tr_b16 v[204:205], v4 offset:0
  ds_read_b64_tr_b16 v[206:207], v4 offset:28672
  ds_read_b64_tr_b16 v[208:209], v4 offset:256
  ds_read_b64_tr_b16 v[210:211], v4 offset:28928
  s_waitcnt lgkmcnt(2)
  v_mfma_f32_32x32x16_bf16 v[140:155], v[204:207], v[8:11], 0
  s_waitcnt lgkmcnt(0)
  v_mfma_f32_32x32x16_bf16 v[156:171], v[208:211], v[8:11], 0
  ds_read_b64_tr_b16 v[204:205], v4 offset:1792
  ds_read_b64_tr_b16 v[206:207], v4 offset:30464
  ds_read_b64_tr_b16 v[208:209], v4 offset:2048
  ds_read_b64_tr_b16 v[210:211], v4 offset:30720
  s_waitcnt lgkmcnt(2)
  v_mfma_f32_32x32x16_bf16 v[140:155], v[204:207], v[12:15], v[140:155]
  s_waitcnt lgkmcnt(0)
  v_mfma_f32_32x32x16_bf16 v[156:171], v[208:211], v[12:15], v[156:171]
  ds_read_b64_tr_b16 v[204:205], v5 offset:0
  ds_read_b64_tr_b16 v[206:207], v5 offset:28672
  ds_read_b64_tr_b16 v[208:209], v5 offset:256
  ds_read_b64_tr_b16 v[210:211], v5 offset:28928
  s_waitcnt lgkmcnt(2)
  v_mfma_f32_32x32x16_bf16 v[140:155], v[204:207], v[16:19], v[140:155]
  s_waitcnt lgkmcnt(0)
  v_mfma_f32_32x32x16_bf16 v[156:171], v[208:211], v[16:19], v[156:171]
  ds_read_b64_tr_b16 v[204:205], v5 offset:1792
  ds_read_b64_tr_b16 v[206:207], v5 offset:30464
  ds_read_b64_tr_b16 v[208:209], v5 offset:2048
  ds_read_b64_tr_b16 v[210:211], v5 offset:30720
  s_waitcnt lgkmcnt(2)
  v_mfma_f32_32x32x16_bf16 v[140:155], v[204:207], v[20:23], v[140:155]
  s_waitcnt lgkmcnt(0)
  v_mfma_f32_32x32x16_bf16 v[156:171], v[208:211], v[20:23], v[156:171]
  ds_read_b64_tr_b16 v[204:205], v4 offset:3584
  ds_read_b64_tr_b16 v[206:207], v4 offset:32256
  ds_read_b64_tr_b16 v[208:209], v4 offset:3840
  ds_read_b64_tr_b16 v[210:211], v4 offset:32512
  s_waitcnt lgkmcnt(2)
  v_mfma_f32_32x32x16_bf16 v[140:155], v[204:207], v[24:27], v[140:155]
  s_waitcnt lgkmcnt(0)
  v_mfma_f32_32x32x16_bf16 v[156:171], v[208:211], v[24:27], v[156:171]
  ds_read_b64_tr_b16 v[204:205], v4 offset:5376
  ds_read_b64_tr_b16 v[206:207], v4 offset:34048
  ds_read_b64_tr_b16 v[208:209], v4 offset:5632
  ds_read_b64_tr_b16 v[210:211], v4 offset:34304
  s_waitcnt lgkmcnt(2)
  v_mfma_f32_32x32x16_bf16 v[140:155], v[204:207], v[28:31], v[140:155]
  s_waitcnt lgkmcnt(0)
  v_mfma_f32_32x32x16_bf16 v[156:171], v[208:211], v[28:31], v[156:171]
  ds_read_b64_tr_b16 v[204:205], v5 offset:3584
  ds_read_b64_tr_b16 v[206:207], v5 offset:32256
  ds_read_b64_tr_b16 v[208:209], v5 offset:3840
  ds_read_b64_tr_b16 v[210:211], v5 offset:32512
  s_waitcnt lgkmcnt(2)
  v_mfma_f32_32x32x16_bf16 v[140:155], v[204:207], v[32:35], v[140:155]
  s_waitcnt lgkmcnt(0)
  v_mfma_f32_32x32x16_bf16 v[156:171], v[208:211], v[32:35], v[156:171]
  ds_read_b64_tr_b16 v[204:205], v5 offset:5376
  ds_read_b64_tr_b16 v[206:207], v5 offset:34048
  ds_read_b64_tr_b16 v[208:209], v5 offset:5632
  ds_read_b64_tr_b16 v[210:211], v5 offset:34304
  s_waitcnt lgkmcnt(2)
  v_mfma_f32_32x32x16_bf16 v[140:155], v[204:207], v[36:39], v[140:155]
  s_waitcnt lgkmcnt(0)
  v_mfma_f32_32x32x16_bf16 v[156:171], v[208:211], v[36:39], v[156:171]
  ds_read_b64_tr_b16 v[204:205], v4 offset:7168
  ds_read_b64_tr_b16 v[206:207], v4 offset:35840
  ds_read_b64_tr_b16 v[208:209], v4 offset:7424
  ds_read_b64_tr_b16 v[210:211], v4 offset:36096
  s_waitcnt lgkmcnt(2)
  v_mfma_f32_32x32x16_bf16 v[140:155], v[204:207], v[40:43], v[140:155]
  s_waitcnt lgkmcnt(0)
  v_mfma_f32_32x32x16_bf16 v[156:171], v[208:211], v[40:43], v[156:171]
  ds_read_b64_tr_b16 v[204:205], v4 offset:8960
  ds_read_b64_tr_b16 v[206:207], v4 offset:37632
  ds_read_b64_tr_b16 v[208:209], v4 offset:9216
  ds_read_b64_tr_b16 v[210:211], v4 offset:37888
  s_waitcnt lgkmcnt(2)
  v_mfma_f32_32x32x16_bf16 v[140:155], v[204:207], v[44:47], v[140:155]
  s_waitcnt lgkmcnt(0)
  v_mfma_f32_32x32x16_bf16 v[156:171], v[208:211], v[44:47], v[156:171]
  ds_read_b64_tr_b16 v[204:205], v5 offset:7168
  ds_read_b64_tr_b16 v[206:207], v5 offset:35840
  ds_read_b64_tr_b16 v[208:209], v5 offset:7424
  ds_read_b64_tr_b16 v[210:211], v5 offset:36096
  s_waitcnt lgkmcnt(2)
  v_mfma_f32_32x32x16_bf16 v[140:155], v[204:207], v[48:51], v[140:155]
  s_waitcnt lgkmcnt(0)
  v_mfma_f32_32x32x16_bf16 v[156:171], v[208:211], v[48:51], v[156:171]
  ds_read_b64_tr_b16 v[204:205], v5 offset:8960
  ds_read_b64_tr_b16 v[206:207], v5 offset:37632
  ds_read_b64_tr_b16 v[208:209], v5 offset:9216
  ds_read_b64_tr_b16 v[210:211], v5 offset:37888
  s_waitcnt lgkmcnt(2)
  v_mfma_f32_32x32x16_bf16 v[140:155], v[204:207], v[52:55], v[140:155]
  s_waitcnt lgkmcnt(0)
  v_mfma_f32_32x32x16_bf16 v[156:171], v[208:211], v[52:55], v[156:171]
  ds_read_b64_tr_b16 v[204:205], v4 offset:10752
  ds_read_b64_tr_b16 v[206:207], v4 offset:39424
  ds_read_b64_tr_b16 v[208:209], v4 offset:11008
  ds_read_b64_tr_b16 v[210:211], v4 offset:39680
  s_waitcnt lgkmcnt(2)
  v_mfma_f32_32x32x16_bf16 v[140:155], v[204:207], v[56:59], v[140:155]
  s_waitcnt lgkmcnt(0)
  v_mfma_f32_32x32x16_bf16 v[156:171], v[208:211], v[56:59], v[156:171]
  ds_read_b64_tr_b16 v[204:205], v4 offset:12544
  ds_read_b64_tr_b16 v[206:207], v4 offset:41216
  ds_read_b64_tr_b16 v[208:209], v4 offset:12800
  ds_read_b64_tr_b16 v[210:211], v4 offset:41472
  s_waitcnt lgkmcnt(2)
  v_mfma_f32_32x32x16_bf16 v[140:155], v[204:207], v[60:63], v[140:155]
  s_waitcnt lgkmcnt(0)
  v_mfma_f32_32x32x16_bf16 v[156:171], v[208:211], v[60:63], v[156:171]
  ds_read_b64_tr_b16 v[204:205], v5 offset:10752
  ds_read_b64_tr_b16 v[206:207], v5 offset:39424
  ds_read_b64_tr_b16 v[208:209], v5 offset:11008
  ds_read_b64_tr_b16 v[210:211], v5 offset:39680
  s_waitcnt lgkmcnt(2)
  v_mfma_f32_32x32x16_bf16 v[140:155], v[204:207], v[64:67], v[140:155]
  s_waitcnt lgkmcnt(0)
  v_mfma_f32_32x32x16_bf16 v[156:171], v[208:211], v[64:67], v[156:171]
  ds_read_b64_tr_b16 v[204:205], v5 offset:12544
  ds_read_b64_tr_b16 v[206:207], v5 offset:41216
  ds_read_b64_tr_b16 v[208:209], v5 offset:12800
  ds_read_b64_tr_b16 v[210:211], v5 offset:41472
  s_waitcnt lgkmcnt(2)
  v_mfma_f32_32x32x16_bf16 v[140:155], v[204:207], v[68:71], v[140:155]
  s_waitcnt lgkmcnt(0)
  v_mfma_f32_32x32x16_bf16 v[156:171], v[208:211], v[68:71], v[156:171]
  ds_read_b64_tr_b16 v[204:205], v4 offset:14336
  ds_read_b64_tr_b16 v[206:207], v4 offset:43008
  ds_read_b64_tr_b16 v[208:209], v4 offset:14592
  ds_read_b64_tr_b16 v[210:211], v4 offset:43264
  s_waitcnt lgkmcnt(2)
  v_mfma_f32_32x32x16_bf16 v[140:155], v[204:207], v[72:75], v[140:155]
  s_waitcnt lgkmcnt(0)
  v_mfma_f32_32x32x16_bf16 v[156:171], v[208:211], v[72:75], v[156:171]
  ds_read_b64_tr_b16 v[204:205], v4 offset:16128
  ds_read_b64_tr_b16 v[206:207], v4 offset:44800
  ds_read_b64_tr_b16 v[208:209], v4 offset:16384
  ds_read_b64_tr_b16 v[210:211], v4 offset:45056
  s_waitcnt lgkmcnt(2)
  v_mfma_f32_32x32x16_bf16 v[140:155], v[204:207], v[76:79], v[140:155]
  s_waitcnt lgkmcnt(0)
  v_mfma_f32_32x32x16_bf16 v[156:171], v[208:211], v[76:79], v[156:171]
  ds_read_b64_tr_b16 v[204:205], v5 offset:14336
  ds_read_b64_tr_b16 v[206:207], v5 offset:43008
  ds_read_b64_tr_b16 v[208:209], v5 offset:14592
  ds_read_b64_tr_b16 v[210:211], v5 offset:43264
  s_waitcnt lgkmcnt(2)
  v_mfma_f32_32x32x16_bf16 v[140:155], v[204:207], v[80:83], v[140:155]
  s_waitcnt lgkmcnt(0)
  v_mfma_f32_32x32x16_bf16 v[156:171], v[208:211], v[80:83], v[156:171]
  ds_read_b64_tr_b16 v[204:205], v5 offset:16128
  ds_read_b64_tr_b16 v[206:207], v5 offset:44800
  ds_read_b64_tr_b16 v[208:209], v5 offset:16384
  ds_read_b64_tr_b16 v[210:211], v5 offset:45056
  s_waitcnt lgkmcnt(2)
  v_mfma_f32_32x32x16_bf16 v[140:155], v[204:207], v[84:87], v[140:155]
  s_waitcnt lgkmcnt(0)
  v_mfma_f32_32x32x16_bf16 v[156:171], v[208:211], v[84:87], v[156:171]
  ds_read_b64_tr_b16 v[204:205], v4 offset:17920
  ds_read_b64_tr_b16 v[206:207], v4 offset:46592
  ds_read_b64_tr_b16 v[208:209], v4 offset:18176
  ds_read_b64_tr_b16 v[210:211], v4 offset:46848
  s_waitcnt lgkmcnt(2)
  v_mfma_f32_32x32x16_bf16 v[140:155], v[204:207], v[88:91], v[140:155]
  s_waitcnt lgkmcnt(0)
  v_mfma_f32_32x32x16_bf16 v[156:171], v[208:211], v[88:91], v[156:171]
  ds_read_b64_tr_b16 v[204:205], v4 offset:19712
  ds_read_b64_tr_b16 v[206:207], v4 offset:48384
  ds_read_b64_tr_b16 v[208:209], v4 offset:19968
  ds_read_b64_tr_b16 v[210:211], v4 offset:48640
  s_waitcnt lgkmcnt(2)
  v_mfma_f32_32x32x16_bf16 v[140:155], v[204:207], v[92:95], v[140:155]
  s_waitcnt lgkmcnt(0)
  v_mfma_f32_32x32x16_bf16 v[156:171], v[208:211], v[92:95], v[156:171]
  ds_read_b64_tr_b16 v[204:205], v5 offset:17920
  ds_read_b64_tr_b16 v[206:207], v5 offset:46592
  ds_read_b64_tr_b16 v[208:209], v5 offset:18176
  ds_read_b64_tr_b16 v[210:211], v5 offset:46848
  s_waitcnt lgkmcnt(2)
  v_mfma_f32_32x32x16_bf16 v[140:155], v[204:207], v[96:99], v[140:155]
  s_waitcnt lgkmcnt(0)
  v_mfma_f32_32x32x16_bf16 v[156:171], v[208:211], v[96:99], v[156:171]
  ds_read_b64_tr_b16 v[204:205], v5 offset:19712
  ds_read_b64_tr_b16 v[206:207], v5 offset:48384
  ds_read_b64_tr_b16 v[208:209], v5 offset:19968
  ds_read_b64_tr_b16 v[210:211], v5 offset:48640
  s_waitcnt lgkmcnt(2)
  v_mfma_f32_32x32x16_bf16 v[140:155], v[204:207], v[100:103], v[140:155]
  s_waitcnt lgkmcnt(0)
  v_mfma_f32_32x32x16_bf16 v[156:171], v[208:211], v[100:103], v[156:171]
  ds_read_b64_tr_b16 v[204:205], v4 offset:21504
  ds_read_b64_tr_b16 v[206:207], v4 offset:50176
  ds_read_b64_tr_b16 v[208:209], v4 offset:21760
  ds_read_b64_tr_b16 v[210:211], v4 offset:50432
  s_waitcnt lgkmcnt(2)
  v_mfma_f32_32x32x16_bf16 v[140:155], v[204:207], v[104:107], v[140:155]
  s_waitcnt lgkmcnt(0)
  v_mfma_f32_32x32x16_bf16 v[156:171], v[208:211], v[104:107], v[156:171]
  ds_read_b64_tr_b16 v[204:205], v4 offset:23296
  ds_read_b64_tr_b16 v[206:207], v4 offset:51968
  ds_read_b64_tr_b16 v[208:209], v4 offset:23552
  ds_read_b64_tr_b16 v[210:211], v4 offset:52224
  s_waitcnt lgkmcnt(2)
  v_mfma_f32_32x32x16_bf16 v[140:155], v[204:207], v[108:111], v[140:155]
  s_waitcnt lgkmcnt(0)
  v_mfma_f32_32x32x16_bf16 v[156:171], v[208:211], v[108:111], v[156:171]
  ds_read_b64_tr_b16 v[204:205], v5 offset:21504
  ds_read_b64_tr_b16 v[206:207], v5 offset:50176
  ds_read_b64_tr_b16 v[208:209], v5 offset:21760
  ds_read_b64_tr_b16 v[210:211], v5 offset:50432
  s_waitcnt lgkmcnt(2)
  v_mfma_f32_32x32x16_bf16 v[140:155], v[204:207], v[112:115], v[140:155]
  s_waitcnt lgkmcnt(0)
  v_mfma_f32_32x32x16_bf16 v[156:171], v[208:211], v[112:115], v[156:171]
  ds_read_b64_tr_b16 v[204:205], v5 offset:23296
  ds_read_b64_tr_b16 v[206:207], v5 offset:51968
  ds_read_b64_tr_b16 v[208:209], v5 offset:23552
  ds_read_b64_tr_b16 v[210:211], v5 offset:52224
  s_waitcnt lgkmcnt(2)
  v_mfma_f32_32x32x16_bf16 v[140:155], v[204:207], v[116:119], v[140:155]
  s_waitcnt lgkmcnt(0)
  v_mfma_f32_32x32x16_bf16 v[156:171], v[208:211], v[116:119], v[156:171]
  ds_read_b64_tr_b16 v[204:205], v4 offset:25088
  ds_read_b64_tr_b16 v[206:207], v4 offset:53760
  ds_read_b64_tr_b16 v[208:209], v4 offset:25344
  ds_read_b64_tr_b16 v[210:211], v4 offset:54016
  s_waitcnt lgkmcnt(2)
  v_mfma_f32_32x32x16_bf16 v[140:155], v[204:207], v[120:123], v[140:155]
  s_waitcnt lgkmcnt(0)
  v_mfma_f32_32x32x16_bf16 v[156:171], v[208:211], v[120:123], v[156:171]
  ds_read_b64_tr_b16 v[204:205], v4 offset:26880
  ds_read_b64_tr_b16 v[206:207], v4 offset:55552
  ds_read_b64_tr_b16 v[208:209], v4 offset:27136
  ds_read_b64_tr_b16 v[210:211], v4 offset:55808
  s_waitcnt lgkmcnt(2)
  v_mfma_f32_32x32x16_bf16 v[140:155], v[204:207], v[124:127], v[140:155]
  s_waitcnt lgkmcnt(0)
  v_mfma_f32_32x32x16_bf16 v[156:171], v[208:211], v[124:127], v[156:171]
  ds_read_b64_tr_b16 v[204:205], v5 offset:25088
  ds_read_b64_tr_b16 v[206:207], v5 offset:53760
  ds_read_b64_tr_b16 v[208:209], v5 offset:25344
  ds_read_b64_tr_b16 v[210:211], v5 offset:54016
  s_waitcnt lgkmcnt(2)
  v_mfma_f32_32x32x16_bf16 v[140:155], v[204:207], v[128:131], v[140:155]
  s_waitcnt lgkmcnt(0)
  v_mfma_f32_32x32x16_bf16 v[156:171], v[208:211], v[128:131], v[156:171]
  ds_read_b64_tr_b16 v[204:205], v5 offset:26880
  ds_read_b64_tr_b16 v[206:207], v5 offset:55552
  ds_read_b64_tr_b16 v[208:209], v5 offset:27136
  ds_read_b64_tr_b16 v[210:211], v5 offset:55808
  s_waitcnt lgkmcnt(2)
  v_mfma_f32_32x32x16_bf16 v[140:155], v[204:207], v[132:135], v[140:155]
  s_waitcnt lgkmcnt(0)
  v_mfma_f32_32x32x16_bf16 v[156:171], v[208:211], v[132:135], v[156:171]
  s_waitcnt vmcnt(0) lgkmcnt(0)
  s_nop 10
  s_branch L_P4AOK
.section .rodata,"a"
.p2align 6
.amdhsa_kernel sequential_preLN__spectral_gfnet__dense_activation_mish__prompt_kernel
  .amdhsa_next_free_vgpr 512
  .amdhsa_next_free_sgpr 102
  .amdhsa_accum_offset 256
  .amdhsa_group_segment_fixed_size 0
  .amdhsa_kernarg_size 80
  .amdhsa_user_sgpr_count 2
  .amdhsa_user_sgpr_kernarg_segment_ptr 1
  .amdhsa_system_sgpr_workgroup_id_x 1
  .amdhsa_float_denorm_mode_32 3
.end_amdhsa_kernel
```
